```python
import torch

def _softmax(x, axis=-1):
    return torch.softmax(x, dim=axis)
def _gelu(x):
    return torch.nn.functional.gelu(x, approximate="tanh")
def _silu(x):
    return torch.nn.functional.silu(x)
def _sigmoid(x):
    return torch.sigmoid(x)
def _layernorm(x, axis=-1, eps=1e-5):
    m = x.mean(dim=axis, keepdim=True)
    v = x.var(dim=axis, keepdim=True, unbiased=False)
    return (x - m) / torch.sqrt(v + eps)
def _scatter_add(tgt, idx, src, axis=0):
    return tgt.clone().index_add_(axis, idx, src)
def _segment_sum(src, seg, n):
    out = torch.zeros((n,) + src.shape[1:], dtype=src.dtype)
    return out.index_add_(0, seg, src)
def _pad(x, pw):
    flat = tuple(v for pair in reversed(pw) for v in pair)
    return torch.nn.functional.pad(x, flat)

kernel_name = 'recurrent_scan__ssm_conv_h3__glu_gated_swiglu__prompt'

def setup_inputs():

    _w = (lambda a: (lambda t: t.to(torch.bfloat16) if t.is_floating_point() else t)(torch.as_tensor(a)))
    def _A_setup():
        B, S, D = 1, 2048, 512
        ks = 4
        return {
            "q": _w((lambda *s: torch.randn(*s, dtype=torch.bfloat16) * 0.05)(B, S, D)),
            "k": _w((lambda *s: torch.randn(*s, dtype=torch.bfloat16) * 0.8)(B, S, D)),
            "v": _w((lambda *s: torch.randn(*s, dtype=torch.bfloat16) * 0.8)(B, S, D)),
            "shift_k": _w((lambda *s: torch.randn(*s, dtype=torch.bfloat16) * 0.8)(D, ks) * 0.5),
            "ssm_k": _w((lambda *s: torch.randn(*s, dtype=torch.bfloat16) * 0.8)(D, S) * (1.0 / S ** 0.5)),
            "ssm_D": _w((lambda *s: torch.randn(*s, dtype=torch.bfloat16) * 0.8)(D)),
        }
    _A_in = _A_setup()

    def _B_setup():
        B, S, D, F = 1, 2048, 512, 1792
        return {
            "x": _w((lambda *s: torch.randn(*s, dtype=torch.bfloat16) * 0.05)(B, S, D)),
            "w1": _w((lambda *s: torch.randn(*s, dtype=torch.bfloat16) * 0.2)(D, F) * (2.0 / D) ** 0.5),
            "w3": _w((lambda *s: torch.randn(*s, dtype=torch.bfloat16) * 0.2)(D, F) * (2.0 / D) ** 0.5),
            "w2": _w((lambda *s: torch.randn(*s, dtype=torch.bfloat16) * 0.2)(F, D) * (2.0 / F) ** 0.5),
        }
    _B_in = _B_setup()

    return {
        "A_q": _A_in["q"],
        "A_k": _A_in["k"],
        "A_v": _A_in["v"],
        "A_shift_k": _A_in["shift_k"],
        "A_ssm_k": _A_in["ssm_k"],
        "A_ssm_D": _A_in["ssm_D"],
        "B_x": _B_in["x"],
        "B_w1": _B_in["w1"],
        "B_w3": _B_in["w3"],
        "B_w2": _B_in["w2"],
    }

def reference(A_q, A_k, A_v, A_shift_k, A_ssm_k, A_ssm_D, B_x, B_w1, B_w3, B_w2):
    def _A_ref(q, k, v, shift_k, ssm_k, ssm_D):
        B, S, D = q.shape
        ks = shift_k.shape[-1]
        k_pad = _pad(k, ((0, 0), (ks - 1, 0), (0, 0)))
        k_shift = torch.zeros_like(k)
        for t in range(ks):
            k_shift = k_shift + k_pad[:, t:t + S, :] * shift_k[:, ks - 1 - t][None, None, :]
        kv = k_shift * v
        L = 2 * S
        kv_pad = _pad(kv, ((0, 0), (0, S), (0, 0)))
        kf_pad = _pad(ssm_k, ((0, 0), (0, S)))
        kv_f = (lambda x, axes=(-2,-1): torch.fft.rfft2(x.float(), dim=axes))(kv_pad[:, None, :, :], axes=(1, 2))
        kf_f = (lambda x, axes=(-2,-1): torch.fft.rfft2(x.float(), dim=axes))(kf_pad[:, None, :], axes=(1, 2))
        kf_f = (lambda x, *d: x.permute(*d))(kf_f, 1, 2, 0)
        y_f = kv_f * kf_f[None, :, :, :]
        y = (lambda x, s, axes=(-2,-1): torch.fft.irfft2(x, s=s, dim=axes).to(torch.bfloat16))(y_f, (1, L), axes=(1, 2))[:, 0, :S, :]
        y = y + kv * ssm_D[None, None, :]
        return q * y

    def _B_ref(x, w1, w3, w2):
        gate = torch.einsum("bsd,df->bsf", x, w1)
        up = torch.einsum("bsd,df->bsf", x, w3)
        h = _silu(gate) * up
        out = torch.einsum("bsf,fd->bsd", h, w2)
        return out

    x = A_q
    xn = _layernorm(x, axis=-1)
    s = _A_ref(xn, A_k, A_v, A_shift_k, A_ssm_k, A_ssm_D)
    g = _silu(_B_ref(xn, B_w1, B_w3, B_w2))
    return x + s * g
```

```asm
; @launch grid=(256,1,1) block=(512,1,1) lds=163840
.amdgcn_target "amdgcn-amd-amdhsa--gfx950"
.text
.globl recurrent_scan__ssm_conv_h3__glu_gated_swiglu__prompt_kernel
.p2align 8
.type recurrent_scan__ssm_conv_h3__glu_gated_swiglu__prompt_kernel,@function
recurrent_scan__ssm_conv_h3__glu_gated_swiglu__prompt_kernel:
    s_cmp_ge_u32 s2, 256
    s_cbranch_scc1 L_END
    s_load_dwordx16 s[4:19], s[0:1], 0
    s_load_dwordx8 s[20:27], s[0:1], 64
    s_load_dwordx2 s[28:29], s[0:1], 96
    v_lshrrev_b32 v2, 6, v0
    v_and_b32 v1, 63, v0
    v_readfirstlane_b32 s100, v2
    s_mov_b32 s96, 100000
    s_and_b32 s80, s100, 3
    s_lshr_b32 s81, s80, 1
    s_and_b32 s82, s80, 1
    s_lshl_b32 s95, s80, 12
    s_cmp_lt_u32 s2, 32
    s_cbranch_scc1 L_HELPER
    s_cmp_lt_u32 s100, 4
    s_cbranch_scc1 L_A
    s_sub_u32 s92, s2, 32
    s_and_b32 s93, s92, 7
    s_lshr_b32 s92, s92, 3
    s_mul_i32 s94, s92, 37
    s_lshr_b32 s94, s94, 8
    s_lshr_b32 s87, s93, 1
    s_lshl_b32 s85, s87, 2
    s_add_u32 s83, s85, s94
    s_lshl_b32 s87, s87, 1
    s_mul_i32 s94, s94, 7
    s_sub_u32 s92, s92, s94
    s_and_b32 s84, s93, 1
    s_mul_i32 s84, s84, 7
    s_add_u32 s84, s84, s92
    v_lshrrev_b32 v16, 3, v1
    s_lshl_b32 s92, s80, 15
    v_lshlrev_b32 v16, 10, v16
    v_add_u32 v16, s92, v16
    v_and_b32 v17, 7, v1
    v_lshrrev_b32 v18, 4, v1
    v_xor_b32 v17, v17, v18
    v_lshl_or_b32 v6, v17, 4, v16
    v_xor_b32 v7, 64, v6
    v_add_u32 v7, 7168, v7
    s_lshl_b32 s92, s82, 2
    v_or_b32 v17, s92, v18
    v_bfe_u32 v16, v1, 1, 3
    v_xor_b32 v16, v16, v17
    s_lshl_b32 s92, s80, 3
    v_add_u32 v17, s92, v18
    v_mul_u32_u24 v17, 3584, v17
    v_lshl_add_u32 v17, v16, 5, v17
    v_and_b32 v16, 1, v1
    v_lshl_add_u32 v4, v16, 4, v17
    v_add_u32 v5, 13312, v4
    s_lshl_b32 s92, s83, 17
    s_lshl_b32 s93, s84, 8
    s_waitcnt lgkmcnt(0)
    s_add_u32 s32, s4, s92
    s_addc_u32 s33, s5, 0
    s_and_b32 s33, s33, 0xffff
    s_mov_b32 s34, 131072
    s_mov_b32 s35, 0x00020000
    s_add_u32 m0, s95, 65536
    s_lshl_b32 s88, s87, 7
    buffer_load_dwordx4 v6, s[32:35], s88 offen offset:0  lds
    buffer_load_dwordx4 v7, s[32:35], s88 offen offset:1024  lds
    s_add_u32 m0, s95, 67584
    s_add_u32 s88, s88, 16384
    buffer_load_dwordx4 v6, s[32:35], s88 offen offset:0  lds
    buffer_load_dwordx4 v7, s[32:35], s88 offen offset:1024  lds
    s_add_u32 s36, s18, s93
    s_addc_u32 s37, s19, 0
    s_and_b32 s37, s37, 0xffff
    s_mov_b32 s38, 1831680
    s_mov_b32 s39, 0x00020000
    s_add_u32 s40, s20, s93
    s_addc_u32 s41, s21, 0
    s_and_b32 s41, s41, 0xffff
    s_mov_b32 s42, 1831680
    s_mov_b32 s43, 0x00020000
    s_add_u32 m0, s95, 0
    s_mul_i32 s86, s85, 114688
    buffer_load_dwordx4 v4, s[36:39], s86 offen offset:0  lds
    buffer_load_dwordx4 v5, s[36:39], s86 offen offset:1024  lds
    s_add_u32 m0, s95, 2048
    s_nop 0
    buffer_load_dwordx4 v4, s[40:43], s86 offen offset:0  lds
    buffer_load_dwordx4 v5, s[40:43], s86 offen offset:1024  lds
    s_add_u32 m0, s95, 16384
    s_add_u32 s86, s86, 114688
    buffer_load_dwordx4 v4, s[36:39], s86 offen offset:0  lds
    buffer_load_dwordx4 v5, s[36:39], s86 offen offset:1024  lds
    s_add_u32 m0, s95, 18432
    s_nop 0
    buffer_load_dwordx4 v4, s[40:43], s86 offen offset:0  lds
    buffer_load_dwordx4 v5, s[40:43], s86 offen offset:1024  lds
    s_and_b32 s6, s83, 3
    v_lshlrev_b32 v30, 4, v1
    s_and_b32 s92, s2, 7
    s_lshr_b32 s93, s2, 3
    s_and_b32 s91, s93, 7
    s_lshr_b32 s93, s93, 3
    s_lshl_b32 s90, s92, 2
    s_add_u32 s90, s90, s93
    s_lshl_b32 s30, s2, 1
    s_add_u32 s30, s30, s81
    s_mov_b32 s48, s28
    s_and_b32 s49, s29, 0xffff
    s_mov_b32 s50, 268435456
    s_mov_b32 s51, 0x00020000
    s_mov_b32 s60, s26
    s_and_b32 s61, s27, 0xffff
    s_mov_b32 s62, 256
    s_mov_b32 s63, 0x00020000
    v_lshrrev_b32 v16, 4, v1
    v_bfe_u32 v17, v1, 2, 2
    v_and_b32 v18, 1, v16
    v_lshl_or_b32 v18, v18, 2, v17
    v_lshlrev_b32 v19, 12, v16
    v_lshl_or_b32 v19, v17, 8, v19
    v_and_b32 v17, 3, v1
    v_lshl_or_b32 v19, v17, 3, v19
    s_lshl_b32 s92, s82, 2
    v_xor_b32 v18, s92, v18
    v_xor_b32 v17, 0, v18
    v_lshl_add_u32 v20, v17, 5, v19
    v_xor_b32 v17, 1, v18
    v_lshl_add_u32 v21, v17, 5, v19
    v_xor_b32 v17, 2, v18
    v_lshl_add_u32 v22, v17, 5, v19
    v_xor_b32 v17, 3, v18
    v_lshl_add_u32 v23, v17, 5, v19
    s_lshl_b32 s92, s81, 11
    v_add_u32 v20, s92, v20
    v_mov_b32 v176, 0x3f803f80
    v_add_u32 v21, s92, v21
    v_mov_b32 v177, 0x3f803f80
    v_add_u32 v22, s92, v22
    v_mov_b32 v178, 0x3f803f80
    v_add_u32 v23, s92, v23
    v_mov_b32 v179, 0x3f803f80
    v_bfe_u32 v24, v1, 2, 2
    v_lshlrev_b32 v24, 10, v24
    v_lshrrev_b32 v25, 4, v1
    v_lshl_or_b32 v24, v25, 6, v24
    v_and_b32 v26, 3, v1
    v_lshl_or_b32 v24, v26, 4, v24
    v_lshlrev_b32 v25, 4, v25
    s_and_b32 s7, s84, 7
    s_lshl_b32 s7, s7, 3
    s_lshl_b32 s92, s81, 6
    s_add_u32 s7, s7, s92
    s_lshl_b32 s92, s82, 2
    s_add_u32 s7, s7, s92
    s_lshl_b32 s10, s7, 10
    s_add_u32 m0, s95, 32768
    s_add_u32 s86, s86, 114688
    buffer_load_dwordx4 v4, s[36:39], s86 offen offset:0  lds
    buffer_load_dwordx4 v5, s[36:39], s86 offen offset:1024  lds
    s_add_u32 m0, s95, 34816
    s_nop 0
    buffer_load_dwordx4 v4, s[40:43], s86 offen offset:0  lds
    buffer_load_dwordx4 v5, s[40:43], s86 offen offset:1024  lds
    s_add_u32 m0, s95, 81920
    s_sub_u32 s88, s88, 16256
    buffer_load_dwordx4 v6, s[32:35], s88 offen offset:0  lds
    buffer_load_dwordx4 v7, s[32:35], s88 offen offset:1024  lds
    s_add_u32 m0, s95, 83968
    s_add_u32 s88, s88, 16384
    buffer_load_dwordx4 v6, s[32:35], s88 offen offset:0  lds
    buffer_load_dwordx4 v7, s[32:35], s88 offen offset:1024  lds
    s_waitcnt vmcnt(12)
    s_waitcnt lgkmcnt(0)
    s_barrier
    s_add_u32 m0, s95, 49152
    s_add_u32 s86, s86, 114688
    buffer_load_dwordx4 v4, s[36:39], s86 offen offset:0  lds
    buffer_load_dwordx4 v5, s[36:39], s86 offen offset:1024  lds
    s_add_u32 m0, s95, 51200
    s_nop 0
    buffer_load_dwordx4 v4, s[40:43], s86 offen offset:0  lds
    buffer_load_dwordx4 v5, s[40:43], s86 offen offset:1024  lds
    s_cmp_lg_u32 s6, 0
    s_cbranch_scc1 CS_1
    ds_read_b64_tr_b16 v[192:193], v20 offset:0
    ds_read_b64_tr_b16 v[194:195], v20 offset:1024
    ds_read_b64_tr_b16 v[196:197], v21 offset:0
    ds_read_b64_tr_b16 v[198:199], v21 offset:1024
    ds_read_b64_tr_b16 v[200:201], v22 offset:0
    ds_read_b64_tr_b16 v[202:203], v22 offset:1024
    ds_read_b64_tr_b16 v[204:205], v23 offset:0
    ds_read_b64_tr_b16 v[206:207], v23 offset:1024
    s_waitcnt lgkmcnt(0)
    s_setprio 3
    v_mfma_f32_16x16x32_bf16 v[208:211], v[192:195], v[176:179], 0
    v_mfma_f32_16x16x32_bf16 v[212:215], v[196:199], v[176:179], 0
    v_mfma_f32_16x16x32_bf16 v[216:219], v[200:203], v[176:179], 0
    v_mfma_f32_16x16x32_bf16 v[220:223], v[204:207], v[176:179], 0
    s_setprio 0
CS_1:
    s_waitcnt vmcnt(12)
    s_waitcnt lgkmcnt(0)
    s_barrier
    s_add_u32 m0, s95, 0
    s_add_u32 s85, s85, 4
    s_and_b32 s85, s85, 15
    s_mul_i32 s86, s85, 114688
    buffer_load_dwordx4 v4, s[36:39], s86 offen offset:0  lds
    buffer_load_dwordx4 v5, s[36:39], s86 offen offset:1024  lds
    s_add_u32 m0, s95, 2048
    s_nop 0
    buffer_load_dwordx4 v4, s[40:43], s86 offen offset:0  lds
    buffer_load_dwordx4 v5, s[40:43], s86 offen offset:1024  lds
    s_add_u32 m0, s95, 98304
    s_add_u32 s87, s87, 2
    s_and_b32 s87, s87, 7
    s_lshl_b32 s88, s87, 7
    buffer_load_dwordx4 v6, s[32:35], s88 offen offset:0  lds
    buffer_load_dwordx4 v7, s[32:35], s88 offen offset:1024  lds
    s_add_u32 m0, s95, 100352
    s_add_u32 s88, s88, 16384
    buffer_load_dwordx4 v6, s[32:35], s88 offen offset:0  lds
    buffer_load_dwordx4 v7, s[32:35], s88 offen offset:1024  lds
    buffer_load_dwordx4 v[160:163], v24, s[32:35], s10 offen offset:0
    buffer_load_dwordx4 v[164:167], v24, s[32:35], s10 offen offset:256
    buffer_load_dwordx4 v[168:171], v24, s[32:35], s10 offen offset:512
    buffer_load_dwordx4 v[172:175], v24, s[32:35], s10 offen offset:768
    s_cmp_lg_u32 s6, 1
    s_cbranch_scc1 CS_2
    ds_read_b64_tr_b16 v[192:193], v20 offset:16384
    ds_read_b64_tr_b16 v[194:195], v20 offset:17408
    ds_read_b64_tr_b16 v[196:197], v21 offset:16384
    ds_read_b64_tr_b16 v[198:199], v21 offset:17408
    ds_read_b64_tr_b16 v[200:201], v22 offset:16384
    ds_read_b64_tr_b16 v[202:203], v22 offset:17408
    ds_read_b64_tr_b16 v[204:205], v23 offset:16384
    ds_read_b64_tr_b16 v[206:207], v23 offset:17408
    s_waitcnt lgkmcnt(0)
    s_setprio 3
    v_mfma_f32_16x16x32_bf16 v[208:211], v[192:195], v[176:179], 0
    v_mfma_f32_16x16x32_bf16 v[212:215], v[196:199], v[176:179], 0
    v_mfma_f32_16x16x32_bf16 v[216:219], v[200:203], v[176:179], 0
    v_mfma_f32_16x16x32_bf16 v[220:223], v[204:207], v[176:179], 0
    s_setprio 0
CS_2:
    s_waitcnt vmcnt(16)
    s_waitcnt lgkmcnt(0)
    s_barrier
    s_add_u32 m0, s95, 16384
    s_add_u32 s86, s86, 114688
    buffer_load_dwordx4 v4, s[36:39], s86 offen offset:0  lds
    buffer_load_dwordx4 v5, s[36:39], s86 offen offset:1024  lds
    s_add_u32 m0, s95, 18432
    s_nop 0
    buffer_load_dwordx4 v4, s[40:43], s86 offen offset:0  lds
    buffer_load_dwordx4 v5, s[40:43], s86 offen offset:1024  lds
    s_add_u32 m0, s95, 65536
    s_sub_u32 s88, s88, 16256
    buffer_load_dwordx4 v6, s[32:35], s88 offen offset:0  lds
    buffer_load_dwordx4 v7, s[32:35], s88 offen offset:1024  lds
    s_cmp_lg_u32 s6, 2
    s_cbranch_scc1 CS_3
    ds_read_b64_tr_b16 v[192:193], v20 offset:32768
    ds_read_b64_tr_b16 v[194:195], v20 offset:33792
    ds_read_b64_tr_b16 v[196:197], v21 offset:32768
    ds_read_b64_tr_b16 v[198:199], v21 offset:33792
    ds_read_b64_tr_b16 v[200:201], v22 offset:32768
    ds_read_b64_tr_b16 v[202:203], v22 offset:33792
    ds_read_b64_tr_b16 v[204:205], v23 offset:32768
    ds_read_b64_tr_b16 v[206:207], v23 offset:33792
    s_waitcnt lgkmcnt(0)
    s_setprio 3
    v_mfma_f32_16x16x32_bf16 v[208:211], v[192:195], v[176:179], 0
    v_mfma_f32_16x16x32_bf16 v[212:215], v[196:199], v[176:179], 0
    v_mfma_f32_16x16x32_bf16 v[216:219], v[200:203], v[176:179], 0
    v_mfma_f32_16x16x32_bf16 v[220:223], v[204:207], v[176:179], 0
    s_setprio 0
CS_3:
    s_waitcnt vmcnt(18)
    s_waitcnt lgkmcnt(0)
    s_barrier
    s_add_u32 m0, s95, 32768
    s_add_u32 s86, s86, 114688
    buffer_load_dwordx4 v4, s[36:39], s86 offen offset:0  lds
    s_cmp_lg_u32 s6, 3
    s_cbranch_scc1 CS_4
    ds_read_b64_tr_b16 v[192:193], v20 offset:49152
    ds_read_b64_tr_b16 v[194:195], v20 offset:50176
    ds_read_b64_tr_b16 v[196:197], v21 offset:49152
    ds_read_b64_tr_b16 v[198:199], v21 offset:50176
    ds_read_b64_tr_b16 v[200:201], v22 offset:49152
    ds_read_b64_tr_b16 v[202:203], v22 offset:50176
    ds_read_b64_tr_b16 v[204:205], v23 offset:49152
    ds_read_b64_tr_b16 v[206:207], v23 offset:50176
    s_waitcnt lgkmcnt(0)
    s_setprio 3
    v_mfma_f32_16x16x32_bf16 v[208:211], v[192:195], v[176:179], 0
    v_mfma_f32_16x16x32_bf16 v[212:215], v[196:199], v[176:179], 0
    v_mfma_f32_16x16x32_bf16 v[216:219], v[200:203], v[176:179], 0
    v_mfma_f32_16x16x32_bf16 v[220:223], v[204:207], v[176:179], 0
    s_setprio 0
CS_4:
    buffer_load_dwordx4 v5, s[36:39], s86 offen offset:1024  lds
    s_waitcnt vmcnt(8)
    s_setprio 3
    v_mfma_f32_16x16x32_bf16 v[180:183], v[160:163], v[160:163], 0
    v_mfma_f32_16x16x32_bf16 v[184:187], v[176:179], v[160:163], 0
    v_mfma_f32_16x16x32_bf16 v[180:183], v[164:167], v[164:167], v[180:183]
    v_mfma_f32_16x16x32_bf16 v[184:187], v[176:179], v[164:167], v[184:187]
    v_mfma_f32_16x16x32_bf16 v[180:183], v[168:171], v[168:171], v[180:183]
    v_mfma_f32_16x16x32_bf16 v[184:187], v[176:179], v[168:171], v[184:187]
    v_mfma_f32_16x16x32_bf16 v[180:183], v[172:175], v[172:175], v[180:183]
    v_mfma_f32_16x16x32_bf16 v[184:187], v[176:179], v[172:175], v[184:187]
    s_setprio 0
    s_nop 6
    s_add_u32 m0, s95, 34816
    s_nop 0
    buffer_load_dwordx4 v4, s[40:43], s86 offen offset:0  lds
    v_cmp_eq_u32 vcc, 1, v26
    s_nop 0
    buffer_load_dwordx4 v5, s[40:43], s86 offen offset:1024  lds
    s_nop 0
    s_add_u32 m0, s95, 67584
    s_add_u32 s88, s88, 16384
    buffer_load_dwordx4 v6, s[32:35], s88 offen offset:0  lds
    v_cndmask_b32 v180, v180, v181, vcc
    buffer_load_dwordx4 v7, s[32:35], s88 offen offset:1024  lds
    v_cndmask_b32 v208, v208, v212, vcc
    buffer_load_dword v27, off, s[60:63], 0 sc1
    s_waitcnt vmcnt(17)
    s_waitcnt lgkmcnt(0)
    s_barrier
    s_add_u32 m0, s95, 49152
    s_add_u32 s86, s86, 114688
    buffer_load_dwordx4 v4, s[36:39], s86 offen offset:0  lds
    v_cndmask_b32 v209, v209, v213, vcc
    v_cndmask_b32 v210, v210, v214, vcc
    v_cndmask_b32 v211, v211, v215, vcc
    v_cmp_eq_u32 vcc, 2, v26
    s_nop 0
    s_nop 0
    v_cndmask_b32 v180, v180, v182, vcc
    v_cndmask_b32 v208, v208, v216, vcc
    v_cndmask_b32 v209, v209, v217, vcc
    v_cndmask_b32 v210, v210, v218, vcc
    v_cndmask_b32 v211, v211, v219, vcc
    buffer_load_dwordx4 v5, s[36:39], s86 offen offset:1024  lds
    v_cmp_eq_u32 vcc, 3, v26
    s_nop 0
    s_nop 0
    v_cndmask_b32 v180, v180, v183, vcc
    v_cndmask_b32 v208, v208, v220, vcc
    v_cndmask_b32 v209, v209, v221, vcc
    v_cndmask_b32 v210, v210, v222, vcc
    v_cndmask_b32 v211, v211, v223, vcc
    v_add_f32_dpp v184, v184, v184 quad_perm:[1,0,3,2] row_mask:0xf bank_mask:0xf
    s_nop 0
    v_add_f32_dpp v180, v180, v180 quad_perm:[1,0,3,2] row_mask:0xf bank_mask:0xf
    s_nop 0
    s_add_u32 m0, s95, 51200
    s_nop 0
    buffer_load_dwordx4 v4, s[40:43], s86 offen offset:0  lds
    v_add_f32_dpp v184, v184, v184 quad_perm:[2,3,0,1] row_mask:0xf bank_mask:0xf
    s_nop 0
    v_add_f32_dpp v180, v180, v180 quad_perm:[2,3,0,1] row_mask:0xf bank_mask:0xf
    s_nop 0
    v_mul_f32 v184, 0xbb000000, v184
    v_mul_f32 v180, 0x3b000000, v180
    v_fma_f32 v180, -v184, v184, v180
    v_max_f32 v180, 0, v180
    v_cvt_pk_bf16_f32 v180, v180, v184
    v_and_b32 v188, 0xffff0000, v180
    v_lshlrev_b32 v180, 16, v180
    v_add_f32 v180, 0x3727c5ac, v180
    buffer_load_dwordx4 v5, s[40:43], s86 offen offset:1024  lds
    v_cvt_pk_bf16_f32 v180, v180, v180
    v_lshlrev_b32 v180, 16, v180
    v_sqrt_f32 v180, v180
    s_nop 0
    v_cvt_pk_bf16_f32 v180, v180, v180
    v_lshlrev_b32 v180, 16, v180
    v_rcp_f32 v191, v180
    v_mul_f32 v190, v180, v180
    v_mul_f32 v189, 0xbfb8aa3b, v191
    s_lshl_b32 s92, s84, 4
    s_add_u32 s92, s92, s83
    s_add_u32 m0, s95, 81920
    s_add_u32 s87, s87, 2
    s_and_b32 s87, s87, 7
    s_lshl_b32 s88, s87, 7
    buffer_load_dwordx4 v6, s[32:35], s88 offen offset:0  lds
    s_lshl_b32 s11, s92, 4
    s_lshl_b32 s92, s92, 10
    s_lshl_b32 s93, s80, 8
    s_add_u32 s92, s92, s93
    s_add_u32 s92, s92, 131072
    v_lshl_or_b32 v24, v26, 6, v25
    v_add_u32 v24, s92, v24
    s_lshl_b32 s93, s80, 2
    s_add_u32 s11, s11, s93
    s_add_u32 s11, s11, 20480
    s_lshl_b32 s92, s83, 7
    s_add_u32 s92, s92, s7
    buffer_load_dwordx4 v7, s[32:35], s88 offen offset:1024  lds
    s_lshl_b32 s92, s92, 4
    s_add_u32 s92, s92, 65536
    v_add_u32 v25, s92, v25
    s_mov_b32 vcc_lo, 0x00100001
    s_mov_b32 vcc_hi, 0x10000100
    s_nop 0
    v_cndmask_b32 v208, v208, v188, vcc
    v_cndmask_b32 v209, v209, v189, vcc
    v_cndmask_b32 v210, v210, v190, vcc
    v_cndmask_b32 v211, v211, v191, vcc
    v_cndmask_b32 v24, v24, v25, vcc
    s_cmp_lt_u32 s84, 8
    s_cselect_b32 s92, 0x00100001, 0
    s_cselect_b32 s93, 0x10000100, 0
    s_or_b32 exec_lo, s92, 0x0f0000f0
    s_or_b32 exec_hi, s93, 0x000ff000
    buffer_store_dwordx4 v[208:211], v24, s[48:51], 0 offen sc1
    s_mov_b64 exec, -1
    s_waitcnt vmcnt(16)
    s_waitcnt lgkmcnt(0)
    s_barrier
    s_add_u32 m0, s95, 0
    s_add_u32 s85, s85, 4
    s_and_b32 s85, s85, 15
    s_mul_i32 s86, s85, 114688
    buffer_load_dwordx4 v4, s[36:39], s86 offen offset:0  lds
    s_waitcnt vmcnt(8)
BACKN_6:
    v_readfirstlane_b32 s89, v27
    s_nop 0
    s_cmp_eq_u32 s89, 0
    s_cbranch_scc1 SLOWN_5
OKN_7:
    s_mov_b32 s52, s12
    s_and_b32 s53, s13, 0xffff
    buffer_load_dwordx4 v5, s[36:39], s86 offen offset:1024  lds
    s_mov_b32 s54, 2097152
    s_mov_b32 s55, 0x00020000
    v_mov_b32 v31, 152064
    s_and_b32 s21, s90, 3
    s_add_u32 m0, s95, 2048
    s_nop 0
    buffer_load_dwordx4 v4, s[40:43], s86 offen offset:0  lds
    s_mul_i32 s21, s21, 7
    s_add_u32 s21, s21, 1
    s_lshr_b32 s21, s21, 1
    s_lshl_b32 s92, s91, 7
    buffer_load_dwordx4 v5, s[40:43], s86 offen offset:1024  lds
    s_add_u32 s44, s22, s92
    s_addc_u32 s45, s23, 0
    s_and_b32 s45, s45, 0xffff
    s_mov_b32 s46, 1834112
    s_mov_b32 s47, 0x00020000
    s_add_u32 m0, s95, 83968
    s_add_u32 s88, s88, 16384
    buffer_load_dwordx4 v6, s[32:35], s88 offen offset:0  lds
    s_mul_i32 s92, s80, 458752
    s_add_u32 s99, s92, 458752
    s_lshl_b32 s93, s21, 15
    s_add_u32 s98, s92, s93
    buffer_load_dwordx4 v7, s[32:35], s88 offen offset:1024  lds
    s_and_b32 s64, s91, 3
    s_xor_b32 s65, s64, 1
    s_xor_b32 s66, s64, 2
    s_xor_b32 s67, s64, 3
    s_waitcnt vmcnt(14)
    s_waitcnt lgkmcnt(0)
    s_barrier
    s_add_u32 m0, s95, 16384
    s_add_u32 s86, s86, 114688
    buffer_load_dwordx4 v4, s[36:39], s86 offen offset:0  lds
    s_mul_i32 s20, s80, 14336
    s_add_u32 s20, s20, 45056
    v_add_u32 v2, s20, v30
    buffer_load_dwordx4 v5, s[36:39], s86 offen offset:1024  lds
    s_mul_i32 s19, s90, 229376
    s_add_u32 s19, s19, 8388608
    s_mul_i32 s93, s80, 14336
    s_add_u32 s69, s19, s93
    s_add_u32 m0, s95, 18432
    s_nop 0
    buffer_load_dwordx4 v4, s[40:43], s86 offen offset:0  lds
    s_sub_u32 s69, s69, s20
    s_lshl_b32 s92, s91, 2
    s_add_u32 s92, s92, s80
    s_mul_i32 s92, s92, 7168
    buffer_load_dwordx4 v5, s[40:43], s86 offen offset:1024  lds
    s_add_u32 s19, s19, s92
    s_lshl_b32 s18, s90, 12
    s_add_u32 s18, s18, 393216
    s_mul_i32 s31, s81, 17408
    s_add_u32 m0, s95, 98304
    s_sub_u32 s88, s88, 16256
    buffer_load_dwordx4 v6, s[32:35], s88 offen offset:0  lds
    s_lshl_b32 s72, s30, 12
    s_lshl_b32 s92, s82, 3
    s_add_u32 s72, s72, s92
    s_add_u32 s73, s72, 4
    buffer_load_dwordx4 v7, s[32:35], s88 offen offset:1024  lds
    s_mul_i32 s74, s82, 8592
    s_add_u32 s74, s74, 224
    s_add_u32 s74, s74, s31
    s_waitcnt vmcnt(12)
    v_mov_b32 v27, s89
    s_mov_b64 exec, 1
    buffer_store_dword v27, off, s[48:51], s11 sc1
    s_mov_b64 exec, -1
    s_waitcnt vmcnt(16)
    s_waitcnt lgkmcnt(0)
    s_barrier
    s_add_u32 m0, s95, 32768
    s_add_u32 s86, s86, 114688
    buffer_load_dwordx4 v4, s[36:39], s86 offen offset:0  lds
    s_mul_i32 s92, s82, 8832
    s_add_u32 s92, s92, 114720
    s_add_u32 s92, s92, s31
    buffer_load_dwordx4 v5, s[36:39], s86 offen offset:1024  lds
    s_mul_i32 s75, s82, 8832
    s_add_u32 s75, s75, 4400
    s_add_u32 s75, s75, s31
    s_mul_i32 s93, s82, 8832
    s_add_u32 m0, s95, 34816
    s_nop 0
    buffer_load_dwordx4 v4, s[40:43], s86 offen offset:0  lds
    s_add_u32 s93, s93, 119136
    s_add_u32 s93, s93, s31
    v_add_u32 v8, s92, v30
    v_add_u32 v9, s93, v30
    buffer_load_dwordx4 v5, s[40:43], s86 offen offset:1024  lds
    v_bfe_u32 v16, v1, 1, 3
    v_add_u32 v17, 7, v16
    v_and_b32 v17, 7, v17
    s_add_u32 m0, s95, 100352
    s_add_u32 s88, s88, 16384
    buffer_load_dwordx4 v6, s[32:35], s88 offen offset:0  lds
    v_lshrrev_b32 v18, 1, v17
    v_and_b32 v17, 1, v17
    v_lshl_add_u32 v17, v18, 2, v17
    v_min_u32 v17, 12, v17
    buffer_load_dwordx4 v7, s[32:35], s88 offen offset:1024  lds
    v_lshlrev_b32 v17, 4, v17
    v_and_b32 v18, 1, v16
    v_mul_u32_u24 v18, 114688, v18
    v_lshrrev_b32 v16, 1, v16
    s_waitcnt vmcnt(13)
    s_waitcnt lgkmcnt(0)
    s_barrier
    s_add_u32 m0, s95, 49152
    s_add_u32 s86, s86, 114688
    buffer_load_dwordx4 v4, s[36:39], s86 offen offset:0  lds
    v_mul_u32_u24 v16, 4352, v16
    v_add3_u32 v17, v16, v17, v18
    v_and_b32 v18, 1, v1
    buffer_load_dwordx4 v5, s[36:39], s86 offen offset:1024  lds
    v_lshl_add_u32 v17, v18, 4, v17
    v_add_u32 v10, s31, v17
    s_lshl_b32 s92, s81, 6
    s_add_u32 s92, s92, 149504
    s_add_u32 m0, s95, 51200
    s_nop 0
    buffer_load_dwordx4 v4, s[40:43], s86 offen offset:0  lds
    v_and_b32 v16, 14, v1
    v_add_u32 v16, 16, v16
    v_mul_u32_u24 v16, v16, v18
    v_add_u32 v12, s92, v16
    buffer_load_dwordx4 v5, s[40:43], s86 offen offset:1024  lds
    v_mov_b32 v13, s92
    v_mov_b32 v14, 0
    v_mov_b32 v15, 0
    s_add_u32 m0, s95, 65536
    s_add_u32 s87, s87, 2
    s_and_b32 s87, s87, 7
    s_lshl_b32 s88, s87, 7
    buffer_load_dwordx4 v6, s[32:35], s88 offen offset:0  lds
    s_mul_i32 s31, s81, 4608
    s_add_u32 s31, s31, 34816
    v_lshl_add_u32 v11, v1, 3, s31
    s_lshl_b32 s92, s82, 11
    buffer_load_dwordx4 v7, s[32:35], s88 offen offset:1024  lds
    s_add_u32 s31, s31, s92
    s_lshl_b32 s93, s30, 12
    s_add_u32 s93, s93, s92
    s_add_u32 s9, s93, 1048576
    s_waitcnt vmcnt(15)
    s_waitcnt lgkmcnt(0)
    s_barrier
    s_add_u32 m0, s95, 0
    s_add_u32 s85, s85, 4
    s_and_b32 s85, s85, 15
    s_mul_i32 s86, s85, 114688
    buffer_load_dwordx4 v4, s[36:39], s86 offen offset:0  lds
    buffer_load_dwordx4 v5, s[36:39], s86 offen offset:1024  lds
    s_add_u32 m0, s95, 2048
    s_nop 0
    buffer_load_dwordx4 v4, s[40:43], s86 offen offset:0  lds
    buffer_load_dwordx4 v5, s[40:43], s86 offen offset:1024  lds
    s_add_u32 m0, s95, 67584
    s_add_u32 s88, s88, 16384
    buffer_load_dwordx4 v6, s[32:35], s88 offen offset:0  lds
    buffer_load_dwordx4 v7, s[32:35], s88 offen offset:1024  lds
    v_lshrrev_b32 v28, 2, v1
    v_lshlrev_b32 v28, 7, v28
    s_sub_u32 s92, s2, 32
    s_lshl_b32 s92, s92, 2
    s_add_u32 s92, s92, s80
    s_lshl_b32 s92, s92, 11
    buffer_load_dword v0, v28, s[44:47], s92 offen
    s_add_u32 s92, s92, 262144
    buffer_load_dword v0, v28, s[52:55], s92 offen
    s_waitcnt vmcnt(14)
    s_waitcnt lgkmcnt(0)
    s_barrier
    s_add_u32 m0, s95, 16384
    s_add_u32 s86, s86, 114688
    buffer_load_dwordx4 v4, s[36:39], s86 offen offset:0  lds
    s_lshl_b32 s22, s80, 12
    s_add_u32 s22, s22, 102400
    s_cmp_eq_u32 s80, 3
    s_cselect_b32 s22, 154112, s22
    v_lshrrev_b32 v17, 3, v1
    buffer_load_dwordx4 v5, s[36:39], s86 offen offset:1024  lds
    v_bfe_u32 v18, v1, 1, 2
    v_bfe_u32 v19, v1, 4, 2
    v_xor_b32 v18, v18, v19
    v_lshlrev_b32 v17, 10, v17
    s_add_u32 m0, s95, 18432
    s_nop 0
    buffer_load_dwordx4 v4, s[40:43], s86 offen offset:0  lds
    v_lshl_or_b32 v17, v18, 5, v17
    v_and_b32 v18, 1, v1
    v_lshl_or_b32 v16, v18, 4, v17
    v_bfe_u32 v17, v1, 2, 3
    v_lshrrev_b32 v18, 5, v1
    buffer_load_dwordx4 v5, s[40:43], s86 offen offset:1024  lds
    v_lshlrev_b32 v18, 10, v18
    v_lshl_or_b32 v18, v17, 7, v18
    v_and_b32 v19, 3, v1
    v_lshl_or_b32 v18, v19, 3, v18
    s_add_u32 m0, s95, 81920
    s_sub_u32 s88, s88, 16256
    buffer_load_dwordx4 v6, s[32:35], s88 offen offset:0  lds
    v_lshrrev_b32 v17, 1, v17
    v_lshl_add_u32 v18, v17, 5, v18
    v_add_u32 v20, s22, v18
    v_xor_b32 v21, 32, v20
    buffer_load_dwordx4 v7, s[32:35], s88 offen offset:1024  lds
    v_xor_b32 v22, 64, v20
    v_xor_b32 v23, 0x60, v20
    v_add_u32 v17, 7168, v16
    v_add_u32 v18, 14336, v16
    v_add_u32 v19, 21504, v16
    s_waitcnt vmcnt(16)
    s_waitcnt lgkmcnt(0)
    s_barrier
    s_add_u32 m0, s95, 32768
    s_add_u32 s86, s86, 114688
    buffer_load_dwordx4 v4, s[36:39], s86 offen offset:0  lds
    buffer_load_dwordx4 v5, s[36:39], s86 offen offset:1024  lds
    s_add_u32 m0, s95, 34816
    s_nop 0
    buffer_load_dwordx4 v4, s[40:43], s86 offen offset:0  lds
    buffer_load_dwordx4 v5, s[40:43], s86 offen offset:1024  lds
    s_add_u32 m0, s95, 83968
    s_add_u32 s88, s88, 16384
    buffer_load_dwordx4 v6, s[32:35], s88 offen offset:0  lds
    buffer_load_dwordx4 v7, s[32:35], s88 offen offset:1024  lds
    v_lshlrev_b32 v25, 2, v1
    s_lshl_b32 s10, s84, 8
    s_add_u32 s10, s10, 20480
    v_bfe_u32 v28, v1, 2, 3
    v_lshlrev_b32 v28, 8, v28
    v_and_b32 v26, 3, v1
    v_lshl_or_b32 v28, v26, 2, v28
    s_lshl_b32 s11, s83, 4
    s_add_u32 s11, s11, 20480
    buffer_load_dword v24, v25, s[48:51], s10 offen sc1
    buffer_load_dword v26, v28, s[48:51], s11 offen sc1
    s_waitcnt vmcnt(16)
    s_waitcnt lgkmcnt(0)
    s_barrier
    s_add_u32 m0, s95, 49152
    s_add_u32 s86, s86, 114688
    buffer_load_dwordx4 v4, s[36:39], s86 offen offset:0  lds
    buffer_load_dwordx4 v5, s[36:39], s86 offen offset:1024  lds
    s_add_u32 m0, s95, 51200
    s_nop 0
    buffer_load_dwordx4 v4, s[40:43], s86 offen offset:0  lds
    buffer_load_dwordx4 v5, s[40:43], s86 offen offset:1024  lds
    s_waitcnt vmcnt(14)
    s_waitcnt lgkmcnt(0)
    s_barrier
    s_waitcnt vmcnt(4)
BACK_9:
    v_xor_b32 v24, s89, v24
    v_xor_b32 v26, s89, v26
    v_or_b32 v24, v24, v26
    v_cmp_ne_u32 vcc, 0, v24
    s_nop 0
    s_cbranch_vccnz SLOW_8
OK_10:
    v_lshrrev_b32 v24, 4, v1
    v_lshlrev_b32 v25, 10, v24
    v_and_b32 v26, 15, v1
    v_lshl_or_b32 v25, v26, 4, v25
    s_lshl_b32 s92, s84, 14
    s_lshl_b32 s93, s80, 8
    s_add_u32 s92, s92, s93
    s_add_u32 s92, s92, 131072
    buffer_load_dwordx4 v[144:147], v25, s[48:51], s92 offen sc1
    s_add_u32 s92, s92, 4096
    buffer_load_dwordx4 v[148:151], v25, s[48:51], s92 offen sc1
    s_add_u32 s92, s92, 4096
    buffer_load_dwordx4 v[152:155], v25, s[48:51], s92 offen sc1
    s_add_u32 s92, s92, 4096
    buffer_load_dwordx4 v[156:159], v25, s[48:51], s92 offen sc1
    s_add_u32 s10, s93, 158208
    s_lshl_b32 s93, s80, 9
    s_add_u32 m0, s93, 159232
    s_lshl_b32 s92, s83, 11
    s_add_u32 s92, s92, s93
    s_add_u32 s92, s92, 65536
    s_mov_b32 exec_hi, 0
    buffer_load_dwordx4 v30, s[48:51], s92 offen sc1 lds
    s_mov_b32 exec_hi, -1
    v_lshrrev_b32 v25, 1, v24
    v_and_b32 v24, 1, v24
    v_lshl_or_b32 v24, v24, 1, v25
    v_lshl_or_b32 v24, v26, 2, v24
    v_lshl_add_u32 v24, v24, 2, s10
    s_lshl_b32 s70, s21, 10
    buffer_load_dwordx4 v[192:195], v30, s[52:55], s72 offen offset:0
    s_add_u32 s32, s69, s70
    buffer_load_dwordx4 v[198:201], v30, s[52:55], s72 offen offset:1024
    s_cmp_eq_u32 s21, 11
    s_cselect_b32 s70, 14336, 0
    buffer_load_dwordx4 v[204:207], v30, s[52:55], s72 offen offset:2048
    s_sub_u32 s33, s32, s70
    buffer_load_dwordx4 v[210:213], v30, s[52:55], s72 offen offset:3072
    s_add_u32 s34, s33, 4096
    s_cmp_eq_u32 s21, 7
    s_cselect_b32 s70, 14336, 0
    s_add_u32 m0, s22, 0
    s_nop 0
    buffer_load_dwordx4 v16, s[44:47], s98 offen offset:0 lds
    s_sub_u32 s35, s34, s70
    buffer_load_dwordx4 v17, s[44:47], s98 offen offset:1024 lds
    s_add_u32 s36, s35, 4096
    buffer_load_dwordx4 v18, s[44:47], s98 offen offset:2048 lds
    s_cmp_eq_u32 s21, 4
    s_cselect_b32 s70, 14336, 0
    buffer_load_dwordx4 v19, s[44:47], s98 offen offset:3072 lds
    s_sub_u32 s37, s36, s70
    s_add_u32 s38, s37, 4096
    s_waitcnt vmcnt(13)
    s_waitcnt lgkmcnt(0)
    s_barrier
    s_waitcnt vmcnt(6)
    s_mov_b64 vcc, 1
    v_cndmask_b32 v196, v192, v198, vcc
    v_cndmask_b32 v197, v193, v199, vcc
    s_nop 0
    v_mov_b32_dpp v196, v196 wave_rol:1 row_mask:0xf bank_mask:0xf
    v_mov_b32_dpp v197, v197 wave_rol:1 row_mask:0xf bank_mask:0xf
    v_alignbit_b32 v160, v193, v192, 16
    v_alignbit_b32 v161, v194, v193, 16
    v_alignbit_b32 v162, v195, v194, 16
    v_alignbit_b32 v163, v196, v195, 16
    v_alignbit_b32 v164, v194, v193, 16
    v_alignbit_b32 v165, v195, v194, 16
    v_alignbit_b32 v166, v196, v195, 16
    v_alignbit_b32 v167, v197, v196, 16
    s_waitcnt vmcnt(5)
    s_mov_b64 vcc, 1
    v_cndmask_b32 v202, v198, v204, vcc
    v_cndmask_b32 v203, v199, v205, vcc
    s_nop 0
    v_mov_b32_dpp v202, v202 wave_rol:1 row_mask:0xf bank_mask:0xf
    v_mov_b32_dpp v203, v203 wave_rol:1 row_mask:0xf bank_mask:0xf
    v_alignbit_b32 v168, v199, v198, 16
    v_alignbit_b32 v169, v200, v199, 16
    v_alignbit_b32 v170, v201, v200, 16
    v_alignbit_b32 v171, v202, v201, 16
    v_alignbit_b32 v172, v200, v199, 16
    v_alignbit_b32 v173, v201, v200, 16
    v_alignbit_b32 v174, v202, v201, 16
    v_alignbit_b32 v175, v203, v202, 16
    s_waitcnt vmcnt(4)
    s_mov_b64 vcc, 1
    v_cndmask_b32 v208, v204, v210, vcc
    v_cndmask_b32 v209, v205, v211, vcc
    s_nop 0
    v_mov_b32_dpp v208, v208 wave_rol:1 row_mask:0xf bank_mask:0xf
    v_mov_b32_dpp v209, v209 wave_rol:1 row_mask:0xf bank_mask:0xf
    v_alignbit_b32 v176, v205, v204, 16
    v_alignbit_b32 v177, v206, v205, 16
    v_alignbit_b32 v178, v207, v206, 16
    v_alignbit_b32 v179, v208, v207, 16
    v_alignbit_b32 v180, v206, v205, 16
    v_alignbit_b32 v181, v207, v206, 16
    v_alignbit_b32 v182, v208, v207, 16
    v_alignbit_b32 v183, v209, v208, 16
    s_waitcnt vmcnt(4)
    s_mov_b64 vcc, 1
    v_cndmask_b32 v214, v210, v210, vcc
    v_cndmask_b32 v215, v211, v211, vcc
    s_nop 0
    v_mov_b32_dpp v214, v214 wave_rol:1 row_mask:0xf bank_mask:0xf
    v_mov_b32_dpp v215, v215 wave_rol:1 row_mask:0xf bank_mask:0xf
    v_alignbit_b32 v184, v211, v210, 16
    v_alignbit_b32 v185, v212, v211, 16
    v_alignbit_b32 v186, v213, v212, 16
    v_alignbit_b32 v187, v214, v213, 16
    v_alignbit_b32 v188, v212, v211, 16
    v_alignbit_b32 v189, v213, v212, 16
    v_alignbit_b32 v190, v214, v213, 16
    v_alignbit_b32 v191, v215, v214, 16
    v_and_b32 v217, 31, v1
    v_lshlrev_b32 v217, 2, v217
    s_lshr_b32 s7, s2, 5
    s_lshl_b32 s7, s7, 7
    s_add_u32 s7, s7, 0
    buffer_load_dword v216, v217, s[48:51], s7 offen sc1
    s_waitcnt vmcnt(10)
    v_add_f32 v144, v144, v148
    v_add_f32 v152, v152, v156
    v_add_f32 v145, v145, v149
    v_add_f32 v153, v153, v157
    v_add_f32 v146, v146, v150
    v_add_f32 v154, v154, v158
    v_add_f32 v147, v147, v151
    v_add_f32 v155, v155, v159
    v_add_f32 v144, v144, v152
    v_add_f32 v145, v145, v153
    v_add_f32 v146, v146, v154
    v_add_f32 v147, v147, v155
    s_nop 0
    v_permlane32_swap_b32 v144, v145
    v_permlane32_swap_b32 v146, v147
    v_add_f32 v144, v144, v145
    v_add_f32 v146, v146, v147
    s_nop 1
    v_permlane16_swap_b32 v144, v146
    v_add_f32 v144, v144, v146
    ds_write_b32 v24, v144
    s_waitcnt vmcnt(9)
    s_waitcnt lgkmcnt(0)
    v_mov_b32 v24, s89
    v_lshl_add_u32 v25, s80, 2, v31
    ds_write_b32 v25, v24 offset:0
    s_waitcnt vmcnt(1)
    ds_read_b64_tr_b16 v[32:33], v20 offset:0
    ds_read_b64_tr_b16 v[34:35], v20 offset:2048
    ds_read_b64_tr_b16 v[36:37], v21 offset:0
    ds_read_b64_tr_b16 v[38:39], v21 offset:2048
    ds_read_b64_tr_b16 v[40:41], v22 offset:0
    ds_read_b64_tr_b16 v[42:43], v22 offset:2048
    ds_read_b64_tr_b16 v[44:45], v23 offset:0
    ds_read_b64_tr_b16 v[46:47], v23 offset:2048
    s_waitcnt lgkmcnt(0)
    s_add_u32 s98, s98, 32768
    s_cmp_eq_u32 s98, s99
    s_cselect_b32 s94, 458752, 0
    s_sub_u32 s98, s98, s94
    s_add_u32 m0, s22, 0
    s_nop 0
    buffer_load_dwordx4 v16, s[44:47], s98 offen offset:0 lds
    buffer_load_dwordx4 v17, s[44:47], s98 offen offset:1024 lds
    buffer_load_dwordx4 v18, s[44:47], s98 offen offset:2048 lds
    buffer_load_dwordx4 v19, s[44:47], s98 offen offset:3072 lds
    ds_write_b128 v8, v[160:163] offset:0
    ds_write_b128 v9, v[164:167] offset:0
    ds_write_b128 v8, v[168:171] offset:1024
    ds_write_b128 v9, v[172:175] offset:1024
    ds_write_b128 v8, v[176:179] offset:2048
    ds_write_b128 v9, v[180:183] offset:2048
    ds_write_b128 v8, v[184:187] offset:3072
    ds_write_b128 v9, v[188:191] offset:3072
    s_cmp_lg_u32 s82, 0
    s_cbranch_scc1 HD_11
    s_mov_b64 exec, 1
    ds_write_b64 v13, v[14:15] offset:0
    ds_write_b64 v13, v[14:15] offset:8
    ds_write_b64 v13, v[14:15] offset:16
    ds_write_b64 v13, v[14:15] offset:24
    ds_write_b128 v13, v[192:195] offset:32
    s_mov_b64 exec, -1
    ds_read_b128 v[24:27], v12
    s_waitcnt lgkmcnt(0)
HD_11:
    ds_read_b128 v[220:223], v31 offset:16
    s_waitcnt lgkmcnt(0)
LB_13:
    v_xor_b32 v220, s89, v220
    v_xor_b32 v221, s89, v221
    v_xor_b32 v222, s89, v222
    v_xor_b32 v223, s89, v223
    v_or3_b32 v221, v221, v222, v223
    v_or_b32 v220, v220, v221
    v_cmp_ne_u32 vcc, 0, v220
    s_nop 0
    s_cbranch_vccnz LS_12
LO_14:
    s_waitcnt vmcnt(4)
BACK_16:
    v_cmp_ne_u32 vcc, s89, v216
    s_nop 0
    s_cbranch_vccnz SLOW_15
OK_17:
    s_mov_b32 m0, s31
    s_nop 0
    buffer_load_dwordx4 v30, s[48:51], s9 offen offset:0 sc1 lds
    buffer_load_dwordx4 v30, s[48:51], s9 offen offset:1024 sc1 lds
L_B1:
    s_add_u32 s98, s98, 32768
    s_cmp_eq_u32 s98, s99
    s_cselect_b32 s94, 458752, 0
    s_sub_u32 s98, s98, s94
    s_add_u32 m0, s20, 0
    s_nop 0
    buffer_load_dwordx4 v16, s[44:47], s98 offen offset:0 lds
    buffer_load_dwordx4 v17, s[44:47], s98 offen offset:1024 lds
    buffer_load_dwordx4 v18, s[44:47], s98 offen offset:2048 lds
    buffer_load_dwordx4 v19, s[44:47], s98 offen offset:3072 lds
    v_add_u32 v8, s74, v30
    v_add_u32 v9, s75, v30
    ds_write_b128 v8, v[192:195] offset:0
    ds_write2_b32 v9, v193, v194 offset0:0 offset1:1
    ds_write2_b32 v9, v195, v196 offset0:2 offset1:3
    ds_write_b128 v8, v[198:201] offset:1024
    v_add_u32 v9, 1024, v9
    ds_write2_b32 v9, v199, v200 offset0:0 offset1:1
    ds_write2_b32 v9, v201, v202 offset0:2 offset1:3
    ds_write_b128 v8, v[204:207] offset:2048
    v_add_u32 v9, 1024, v9
    ds_write2_b32 v9, v205, v206 offset0:0 offset1:1
    ds_write2_b32 v9, v207, v208 offset0:2 offset1:3
    ds_write_b128 v8, v[210:213] offset:3072
    v_add_u32 v9, 1024, v9
    ds_write2_b32 v9, v211, v212 offset0:0 offset1:1
    ds_write2_b32 v9, v213, v214 offset0:2 offset1:3
    ds_write_b64 v11, v[14:15] offset:4096
    s_cmp_lg_u32 s82, 0
    s_cbranch_scc1 HD_18
    ds_write_b128 v10, v[24:27]
HD_18:
    s_waitcnt vmcnt(6)
    ds_read_b64_tr_b16 v[48:49], v20 offset:0
    ds_read_b64_tr_b16 v[50:51], v20 offset:2048
    ds_read_b64_tr_b16 v[52:53], v21 offset:0
    ds_read_b64_tr_b16 v[54:55], v21 offset:2048
    ds_read_b64_tr_b16 v[56:57], v22 offset:0
    ds_read_b64_tr_b16 v[58:59], v22 offset:2048
    ds_read_b64_tr_b16 v[60:61], v23 offset:0
    ds_read_b64_tr_b16 v[62:63], v23 offset:2048
    s_waitcnt lgkmcnt(0)
    s_waitcnt vmcnt(4)
    v_mov_b32 v24, s89
    v_lshl_add_u32 v25, s80, 2, v31
    ds_write_b32 v25, v24 offset:32
    v_min_u32 v25, 27, v1
    v_lshlrev_b32 v25, 7, v25
    v_min_u32 v26, 55, v1
    v_lshlrev_b32 v26, 7, v26
    s_add_u32 s98, s98, 32768
    s_cmp_eq_u32 s98, s99
    s_cselect_b32 s94, 458752, 0
    s_sub_u32 s98, s98, s94
    s_add_u32 m0, s20, 4096
    s_nop 0
    buffer_load_dwordx4 v16, s[44:47], s98 offen offset:0 lds
    buffer_load_dwordx4 v17, s[44:47], s98 offen offset:1024 lds
    buffer_load_dwordx4 v18, s[44:47], s98 offen offset:2048 lds
    buffer_load_dwordx4 v19, s[44:47], s98 offen offset:3072 lds
    s_add_u32 s98, s98, 32768
    s_cmp_eq_u32 s98, s99
    s_cselect_b32 s94, 458752, 0
    s_sub_u32 s98, s98, s94
    s_add_u32 m0, s20, 8192
    s_nop 0
    buffer_load_dwordx4 v16, s[44:47], s98 offen offset:0 lds
    buffer_load_dwordx4 v17, s[44:47], s98 offen offset:1024 lds
    buffer_load_dwordx4 v18, s[44:47], s98 offen offset:2048 lds
    buffer_load_dwordx4 v19, s[44:47], s98 offen offset:3072 lds
    s_sub_u32 s92, s20, s22
    v_add_u32 v20, s92, v20
    v_add_u32 v21, s92, v21
    v_add_u32 v22, s92, v22
    v_add_u32 v23, s92, v23
    s_waitcnt vmcnt(8)
    ds_read_b64_tr_b16 v[64:65], v20 offset:0
    ds_read_b64_tr_b16 v[66:67], v20 offset:2048
    ds_read_b64_tr_b16 v[68:69], v21 offset:0
    ds_read_b64_tr_b16 v[70:71], v21 offset:2048
    ds_read_b64_tr_b16 v[72:73], v22 offset:0
    ds_read_b64_tr_b16 v[74:75], v22 offset:2048
    ds_read_b64_tr_b16 v[76:77], v23 offset:0
    ds_read_b64_tr_b16 v[78:79], v23 offset:2048
    s_waitcnt lgkmcnt(0)
    s_add_u32 s98, s98, 32768
    s_cmp_eq_u32 s98, s99
    s_cselect_b32 s94, 458752, 0
    s_sub_u32 s98, s98, s94
    s_add_u32 m0, s20, 0
    s_nop 0
    buffer_load_dwordx4 v16, s[44:47], s98 offen offset:0 lds
    buffer_load_dwordx4 v17, s[44:47], s98 offen offset:1024 lds
    buffer_load_dwordx4 v18, s[44:47], s98 offen offset:2048 lds
    buffer_load_dwordx4 v19, s[44:47], s98 offen offset:3072 lds
    s_waitcnt vmcnt(8)
    ds_read_b64_tr_b16 v[80:81], v20 offset:4096
    ds_read_b64_tr_b16 v[82:83], v20 offset:6144
    ds_read_b64_tr_b16 v[84:85], v21 offset:4096
    ds_read_b64_tr_b16 v[86:87], v21 offset:6144
    ds_read_b64_tr_b16 v[88:89], v22 offset:4096
    ds_read_b64_tr_b16 v[90:91], v22 offset:6144
    ds_read_b64_tr_b16 v[92:93], v23 offset:4096
    ds_read_b64_tr_b16 v[94:95], v23 offset:6144
    s_waitcnt lgkmcnt(0)
    s_add_u32 s98, s98, 32768
    s_cmp_eq_u32 s98, s99
    s_cselect_b32 s94, 458752, 0
    s_sub_u32 s98, s98, s94
    s_add_u32 m0, s20, 4096
    s_nop 0
    buffer_load_dwordx4 v16, s[44:47], s98 offen offset:0 lds
    buffer_load_dwordx4 v17, s[44:47], s98 offen offset:1024 lds
    buffer_load_dwordx4 v18, s[44:47], s98 offen offset:2048 lds
    buffer_load_dwordx4 v19, s[44:47], s98 offen offset:3072 lds
    s_waitcnt vmcnt(8)
    ds_read_b64_tr_b16 v[96:97], v20 offset:8192
    ds_read_b64_tr_b16 v[98:99], v20 offset:10240
    ds_read_b64_tr_b16 v[100:101], v21 offset:8192
    ds_read_b64_tr_b16 v[102:103], v21 offset:10240
    ds_read_b64_tr_b16 v[104:105], v22 offset:8192
    ds_read_b64_tr_b16 v[106:107], v22 offset:10240
    ds_read_b64_tr_b16 v[108:109], v23 offset:8192
    ds_read_b64_tr_b16 v[110:111], v23 offset:10240
    s_waitcnt lgkmcnt(0)
    s_add_u32 s98, s98, 32768
    s_cmp_eq_u32 s98, s99
    s_cselect_b32 s94, 458752, 0
    s_sub_u32 s98, s98, s94
    s_add_u32 m0, s20, 8192
    s_nop 0
    buffer_load_dwordx4 v16, s[44:47], s98 offen offset:0 lds
    buffer_load_dwordx4 v17, s[44:47], s98 offen offset:1024 lds
    buffer_load_dwordx4 v18, s[44:47], s98 offen offset:2048 lds
    buffer_load_dwordx4 v19, s[44:47], s98 offen offset:3072 lds
    s_waitcnt vmcnt(8)
    ds_read_b64_tr_b16 v[112:113], v20 offset:0
    ds_read_b64_tr_b16 v[114:115], v20 offset:2048
    ds_read_b64_tr_b16 v[116:117], v21 offset:0
    ds_read_b64_tr_b16 v[118:119], v21 offset:2048
    ds_read_b64_tr_b16 v[120:121], v22 offset:0
    ds_read_b64_tr_b16 v[122:123], v22 offset:2048
    ds_read_b64_tr_b16 v[124:125], v23 offset:0
    ds_read_b64_tr_b16 v[126:127], v23 offset:2048
    s_waitcnt lgkmcnt(0)
    s_add_u32 s98, s98, 32768
    s_cmp_eq_u32 s98, s99
    s_cselect_b32 s94, 458752, 0
    s_sub_u32 s98, s98, s94
    s_add_u32 m0, s20, 0
    s_nop 0
    buffer_load_dwordx4 v16, s[44:47], s98 offen offset:0 lds
    buffer_load_dwordx4 v17, s[44:47], s98 offen offset:1024 lds
    buffer_load_dwordx4 v18, s[44:47], s98 offen offset:2048 lds
    buffer_load_dwordx4 v19, s[44:47], s98 offen offset:3072 lds
    s_waitcnt vmcnt(8)
    ds_read_b64_tr_b16 v[128:129], v20 offset:4096
    ds_read_b64_tr_b16 v[130:131], v20 offset:6144
    ds_read_b64_tr_b16 v[132:133], v21 offset:4096
    ds_read_b64_tr_b16 v[134:135], v21 offset:6144
    ds_read_b64_tr_b16 v[136:137], v22 offset:4096
    ds_read_b64_tr_b16 v[138:139], v22 offset:6144
    ds_read_b64_tr_b16 v[140:141], v23 offset:4096
    ds_read_b64_tr_b16 v[142:143], v23 offset:6144
    s_waitcnt lgkmcnt(0)
    s_add_u32 s98, s98, 32768
    s_cmp_eq_u32 s98, s99
    s_cselect_b32 s94, 458752, 0
    s_sub_u32 s98, s98, s94
    s_add_u32 m0, s20, 4096
    s_nop 0
    buffer_load_dwordx4 v16, s[44:47], s98 offen offset:0 lds
    buffer_load_dwordx4 v17, s[44:47], s98 offen offset:1024 lds
    buffer_load_dwordx4 v18, s[44:47], s98 offen offset:2048 lds
    buffer_load_dwordx4 v19, s[44:47], s98 offen offset:3072 lds
    s_waitcnt vmcnt(8)
    ds_read_b64_tr_b16 v[144:145], v20 offset:8192
    ds_read_b64_tr_b16 v[146:147], v20 offset:10240
    ds_read_b64_tr_b16 v[148:149], v21 offset:8192
    ds_read_b64_tr_b16 v[150:151], v21 offset:10240
    ds_read_b64_tr_b16 v[152:153], v22 offset:8192
    ds_read_b64_tr_b16 v[154:155], v22 offset:10240
    ds_read_b64_tr_b16 v[156:157], v23 offset:8192
    ds_read_b64_tr_b16 v[158:159], v23 offset:10240
    s_waitcnt lgkmcnt(0)
    s_add_u32 s98, s98, 32768
    s_cmp_eq_u32 s98, s99
    s_cselect_b32 s94, 458752, 0
    s_sub_u32 s98, s98, s94
    s_add_u32 m0, s20, 8192
    s_nop 0
    buffer_load_dwordx4 v16, s[44:47], s98 offen offset:0 lds
    buffer_load_dwordx4 v17, s[44:47], s98 offen offset:1024 lds
    buffer_load_dwordx4 v18, s[44:47], s98 offen offset:2048 lds
    buffer_load_dwordx4 v19, s[44:47], s98 offen offset:3072 lds
    ds_read_b128 v[8:11], v31 offset:48
    s_waitcnt lgkmcnt(0)
LB_20:
    v_xor_b32 v8, s89, v8
    v_xor_b32 v9, s89, v9
    v_xor_b32 v10, s89, v10
    v_xor_b32 v11, s89, v11
    v_or3_b32 v9, v9, v10, v11
    v_or_b32 v8, v8, v9
    v_cmp_ne_u32 vcc, 0, v8
    s_nop 0
    s_cbranch_vccnz LS_19
LO_21:
    buffer_load_dword v24, v25, s[48:51], s18 offen sc1
    s_waitcnt vmcnt(9)
    ds_read_b64_tr_b16 v[160:161], v20 offset:0
    ds_read_b64_tr_b16 v[162:163], v20 offset:2048
    ds_read_b64_tr_b16 v[164:165], v21 offset:0
    ds_read_b64_tr_b16 v[166:167], v21 offset:2048
    ds_read_b64_tr_b16 v[168:169], v22 offset:0
    ds_read_b64_tr_b16 v[170:171], v22 offset:2048
    ds_read_b64_tr_b16 v[172:173], v23 offset:0
    ds_read_b64_tr_b16 v[174:175], v23 offset:2048
    s_waitcnt lgkmcnt(0)
    s_add_u32 s98, s98, 32768
    s_cmp_eq_u32 s98, s99
    s_cselect_b32 s94, 458752, 0
    s_sub_u32 s98, s98, s94
    s_add_u32 m0, s20, 0
    s_nop 0
    buffer_load_dwordx4 v16, s[44:47], s98 offen offset:0 lds
    buffer_load_dwordx4 v17, s[44:47], s98 offen offset:1024 lds
    buffer_load_dwordx4 v18, s[44:47], s98 offen offset:2048 lds
    buffer_load_dwordx4 v19, s[44:47], s98 offen offset:3072 lds
    s_waitcnt vmcnt(9)
    ds_read_b64_tr_b16 v[176:177], v20 offset:4096
    ds_read_b64_tr_b16 v[178:179], v20 offset:6144
    ds_read_b64_tr_b16 v[180:181], v21 offset:4096
    ds_read_b64_tr_b16 v[182:183], v21 offset:6144
    ds_read_b64_tr_b16 v[184:185], v22 offset:4096
    ds_read_b64_tr_b16 v[186:187], v22 offset:6144
    ds_read_b64_tr_b16 v[188:189], v23 offset:4096
    ds_read_b64_tr_b16 v[190:191], v23 offset:6144
    s_waitcnt lgkmcnt(0)
    s_add_u32 s98, s98, 32768
    s_cmp_eq_u32 s98, s99
    s_cselect_b32 s94, 458752, 0
    s_sub_u32 s98, s98, s94
    s_add_u32 m0, s20, 4096
    s_nop 0
    buffer_load_dwordx4 v16, s[44:47], s98 offen offset:0 lds
    buffer_load_dwordx4 v17, s[44:47], s98 offen offset:1024 lds
    buffer_load_dwordx4 v18, s[44:47], s98 offen offset:2048 lds
    buffer_load_dwordx4 v19, s[44:47], s98 offen offset:3072 lds
    s_waitcnt vmcnt(9)
    ds_read_b64_tr_b16 v[192:193], v20 offset:8192
    ds_read_b64_tr_b16 v[194:195], v20 offset:10240
    ds_read_b64_tr_b16 v[196:197], v21 offset:8192
    ds_read_b64_tr_b16 v[198:199], v21 offset:10240
    ds_read_b64_tr_b16 v[200:201], v22 offset:8192
    ds_read_b64_tr_b16 v[202:203], v22 offset:10240
    ds_read_b64_tr_b16 v[204:205], v23 offset:8192
    ds_read_b64_tr_b16 v[206:207], v23 offset:10240
    s_waitcnt lgkmcnt(0)
    s_add_u32 s98, s98, 32768
    s_cmp_eq_u32 s98, s99
    s_cselect_b32 s94, 458752, 0
    s_sub_u32 s98, s98, s94
    s_add_u32 m0, s20, 8192
    s_nop 0
    buffer_load_dwordx4 v16, s[44:47], s98 offen offset:0 lds
    buffer_load_dwordx4 v17, s[44:47], s98 offen offset:1024 lds
    buffer_load_dwordx4 v18, s[44:47], s98 offen offset:2048 lds
    buffer_load_dwordx4 v19, s[44:47], s98 offen offset:3072 lds
    v_lshrrev_b32 v27, 4, v1
    v_and_b32 v28, 15, v1
    v_and_b32 v29, 7, v28
    v_xor_b32 v27, v27, v29
    v_lshlrev_b32 v28, 8, v28
    v_lshl_or_b32 v28, v27, 4, v28
    v_add_u32 v1, s95, v28
    s_waitcnt vmcnt(12)
BACK_23:
    v_cmp_ne_u32 vcc, s89, v24
    s_nop 0
    s_cbranch_vccnz SLOW_22
OK_24:
    v_mov_b32 v24, s89
    v_lshl_add_u32 v25, s80, 2, v31
    ds_write_b32 v25, v24 offset:80
    s_waitcnt vmcnt(8)
    ds_read_b64_tr_b16 v[208:209], v20 offset:0
    ds_read_b64_tr_b16 v[210:211], v20 offset:2048
    ds_read_b64_tr_b16 v[212:213], v21 offset:0
    ds_read_b64_tr_b16 v[214:215], v21 offset:2048
    ds_read_b64_tr_b16 v[216:217], v22 offset:0
    ds_read_b64_tr_b16 v[218:219], v22 offset:2048
    ds_read_b64_tr_b16 v[220:221], v23 offset:0
    ds_read_b64_tr_b16 v[222:223], v23 offset:2048
    s_waitcnt lgkmcnt(0)
    s_mul_i32 s68, s64, 57344
    s_add_u32 m0, s20, 0
    s_add_u32 s70, s68, s32
    buffer_load_dwordx4 v2, s[48:51], s70 offen offset:0 sc1 lds
    s_add_u32 s70, s68, s32
    buffer_load_dwordx4 v2, s[48:51], s70 offen offset:1024 sc1 lds
    s_add_u32 s70, s68, s32
    buffer_load_dwordx4 v2, s[48:51], s70 offen offset:2048 sc1 lds
    s_add_u32 s70, s68, s33
    buffer_load_dwordx4 v2, s[48:51], s70 offen offset:3072 sc1 lds
    s_waitcnt vmcnt(8)
    ds_read_b64_tr_b16 a[0:1], v20 offset:4096
    ds_read_b64_tr_b16 a[2:3], v20 offset:6144
    ds_read_b64_tr_b16 a[4:5], v21 offset:4096
    ds_read_b64_tr_b16 a[6:7], v21 offset:6144
    ds_read_b64_tr_b16 a[8:9], v22 offset:4096
    ds_read_b64_tr_b16 a[10:11], v22 offset:6144
    ds_read_b64_tr_b16 a[12:13], v23 offset:4096
    ds_read_b64_tr_b16 a[14:15], v23 offset:6144
    s_waitcnt lgkmcnt(0)
    s_add_u32 m0, s20, 4096
    s_add_u32 s70, s68, s34
    buffer_load_dwordx4 v2, s[48:51], s70 offen offset:0 sc1 lds
    s_add_u32 s70, s68, s34
    buffer_load_dwordx4 v2, s[48:51], s70 offen offset:1024 sc1 lds
    s_add_u32 s70, s68, s34
    buffer_load_dwordx4 v2, s[48:51], s70 offen offset:2048 sc1 lds
    s_add_u32 s70, s68, s35
    buffer_load_dwordx4 v2, s[48:51], s70 offen offset:3072 sc1 lds
    s_waitcnt vmcnt(8)
    ds_read_b64_tr_b16 a[16:17], v20 offset:8192
    ds_read_b64_tr_b16 a[18:19], v20 offset:10240
    ds_read_b64_tr_b16 a[20:21], v21 offset:8192
    ds_read_b64_tr_b16 a[22:23], v21 offset:10240
    ds_read_b64_tr_b16 a[24:25], v22 offset:8192
    ds_read_b64_tr_b16 a[26:27], v22 offset:10240
    ds_read_b64_tr_b16 a[28:29], v23 offset:8192
    ds_read_b64_tr_b16 a[30:31], v23 offset:10240
    s_waitcnt lgkmcnt(0)
    s_add_u32 m0, s20, 8192
    s_add_u32 s70, s68, s36
    buffer_load_dwordx4 v2, s[48:51], s70 offen offset:0 sc1 lds
    s_add_u32 s70, s68, s36
    buffer_load_dwordx4 v2, s[48:51], s70 offen offset:1024 sc1 lds
    s_add_u32 s70, s68, s37
    buffer_load_dwordx4 v2, s[48:51], s70 offen offset:2048 sc1 lds
    s_add_u32 s70, s68, s37
    buffer_load_dwordx4 v2, s[48:51], s70 offen offset:3072 sc1 lds
    s_add_u32 m0, s20, 12288
    s_add_u32 s70, s68, s38
    buffer_load_dwordx4 v2, s[48:51], s70 offen offset:0 sc1 lds
    s_add_u32 s70, s68, s38
    buffer_load_dwordx4 v2, s[48:51], s70 offen offset:1024 sc1 lds
    s_setprio 2
    s_waitcnt vmcnt(13)
    ds_read_b128 v[4:7], v2 offset:0
    s_waitcnt vmcnt(12)
    ds_read_b128 v[8:11], v2 offset:1024
    s_waitcnt vmcnt(11) lgkmcnt(1)
    v_mfma_f32_16x16x32_bf16 v[16:19], v[32:35], v[4:7], 0
    ds_read_b128 v[12:15], v2 offset:2048
    v_mfma_f32_16x16x32_bf16 v[20:23], v[36:39], v[4:7], 0
    s_mul_i32 s68, s65, 57344
    s_add_u32 m0, s20, 0
    s_add_u32 s70, s68, s32
    v_mfma_f32_16x16x32_bf16 v[24:27], v[40:43], v[4:7], 0
    buffer_load_dwordx4 v2, s[48:51], s70 offen offset:0 sc1 lds
    v_mfma_f32_16x16x32_bf16 v[28:31], v[44:47], v[4:7], 0
    s_waitcnt vmcnt(11) lgkmcnt(1)
    v_mfma_f32_16x16x32_bf16 v[16:19], v[48:51], v[8:11], v[16:19]
    ds_read_b128 v[4:7], v2 offset:3072
    v_mfma_f32_16x16x32_bf16 v[20:23], v[52:55], v[8:11], v[20:23]
    s_add_u32 s70, s68, s32
    v_mfma_f32_16x16x32_bf16 v[24:27], v[56:59], v[8:11], v[24:27]
    buffer_load_dwordx4 v2, s[48:51], s70 offen offset:1024 sc1 lds
    v_mfma_f32_16x16x32_bf16 v[28:31], v[60:63], v[8:11], v[28:31]
    s_waitcnt vmcnt(11) lgkmcnt(1)
    v_mfma_f32_16x16x32_bf16 v[16:19], v[64:67], v[12:15], v[16:19]
    ds_read_b128 v[8:11], v2 offset:4096
    v_mfma_f32_16x16x32_bf16 v[20:23], v[68:71], v[12:15], v[20:23]
    s_add_u32 s70, s68, s32
    v_mfma_f32_16x16x32_bf16 v[24:27], v[72:75], v[12:15], v[24:27]
    buffer_load_dwordx4 v2, s[48:51], s70 offen offset:2048 sc1 lds
    v_mfma_f32_16x16x32_bf16 v[28:31], v[76:79], v[12:15], v[28:31]
    s_waitcnt vmcnt(11) lgkmcnt(1)
    v_mfma_f32_16x16x32_bf16 v[16:19], v[80:83], v[4:7], v[16:19]
    ds_read_b128 v[12:15], v2 offset:5120
    v_mfma_f32_16x16x32_bf16 v[20:23], v[84:87], v[4:7], v[20:23]
    s_add_u32 s70, s68, s33
    v_mfma_f32_16x16x32_bf16 v[24:27], v[88:91], v[4:7], v[24:27]
    buffer_load_dwordx4 v2, s[48:51], s70 offen offset:3072 sc1 lds
    v_mfma_f32_16x16x32_bf16 v[28:31], v[92:95], v[4:7], v[28:31]
    s_waitcnt vmcnt(11) lgkmcnt(1)
    v_mfma_f32_16x16x32_bf16 v[16:19], v[96:99], v[8:11], v[16:19]
    ds_read_b128 v[4:7], v2 offset:6144
    v_mfma_f32_16x16x32_bf16 v[20:23], v[100:103], v[8:11], v[20:23]
    s_add_u32 m0, s20, 4096
    s_add_u32 s70, s68, s34
    v_mfma_f32_16x16x32_bf16 v[24:27], v[104:107], v[8:11], v[24:27]
    buffer_load_dwordx4 v2, s[48:51], s70 offen offset:0 sc1 lds
    v_mfma_f32_16x16x32_bf16 v[28:31], v[108:111], v[8:11], v[28:31]
    s_waitcnt vmcnt(11) lgkmcnt(1)
    v_mfma_f32_16x16x32_bf16 v[16:19], v[112:115], v[12:15], v[16:19]
    ds_read_b128 v[8:11], v2 offset:7168
    v_mfma_f32_16x16x32_bf16 v[20:23], v[116:119], v[12:15], v[20:23]
    s_add_u32 s70, s68, s34
    v_mfma_f32_16x16x32_bf16 v[24:27], v[120:123], v[12:15], v[24:27]
    buffer_load_dwordx4 v2, s[48:51], s70 offen offset:1024 sc1 lds
    v_mfma_f32_16x16x32_bf16 v[28:31], v[124:127], v[12:15], v[28:31]
    s_waitcnt vmcnt(11) lgkmcnt(1)
    v_mfma_f32_16x16x32_bf16 v[16:19], v[128:131], v[4:7], v[16:19]
    ds_read_b128 v[12:15], v2 offset:8192
    v_mfma_f32_16x16x32_bf16 v[20:23], v[132:135], v[4:7], v[20:23]
    s_add_u32 s70, s68, s34
    v_mfma_f32_16x16x32_bf16 v[24:27], v[136:139], v[4:7], v[24:27]
    buffer_load_dwordx4 v2, s[48:51], s70 offen offset:2048 sc1 lds
    v_mfma_f32_16x16x32_bf16 v[28:31], v[140:143], v[4:7], v[28:31]
    s_waitcnt vmcnt(11) lgkmcnt(1)
    v_mfma_f32_16x16x32_bf16 v[16:19], v[144:147], v[8:11], v[16:19]
    ds_read_b128 v[4:7], v2 offset:9216
    v_mfma_f32_16x16x32_bf16 v[20:23], v[148:151], v[8:11], v[20:23]
    s_add_u32 s70, s68, s35
    v_mfma_f32_16x16x32_bf16 v[24:27], v[152:155], v[8:11], v[24:27]
    buffer_load_dwordx4 v2, s[48:51], s70 offen offset:3072 sc1 lds
    v_mfma_f32_16x16x32_bf16 v[28:31], v[156:159], v[8:11], v[28:31]
    s_waitcnt vmcnt(11) lgkmcnt(1)
    v_mfma_f32_16x16x32_bf16 v[16:19], v[160:163], v[12:15], v[16:19]
    ds_read_b128 v[8:11], v2 offset:10240
    v_mfma_f32_16x16x32_bf16 v[20:23], v[164:167], v[12:15], v[20:23]
    s_add_u32 m0, s20, 8192
    s_add_u32 s70, s68, s36
    v_mfma_f32_16x16x32_bf16 v[24:27], v[168:171], v[12:15], v[24:27]
    buffer_load_dwordx4 v2, s[48:51], s70 offen offset:0 sc1 lds
    v_mfma_f32_16x16x32_bf16 v[28:31], v[172:175], v[12:15], v[28:31]
    s_waitcnt vmcnt(11) lgkmcnt(1)
    v_mfma_f32_16x16x32_bf16 v[16:19], v[176:179], v[4:7], v[16:19]
    ds_read_b128 v[12:15], v2 offset:11264
    v_mfma_f32_16x16x32_bf16 v[20:23], v[180:183], v[4:7], v[20:23]
    s_add_u32 s70, s68, s36
    v_mfma_f32_16x16x32_bf16 v[24:27], v[184:187], v[4:7], v[24:27]
    buffer_load_dwordx4 v2, s[48:51], s70 offen offset:1024 sc1 lds
    v_mfma_f32_16x16x32_bf16 v[28:31], v[188:191], v[4:7], v[28:31]
    s_waitcnt vmcnt(11) lgkmcnt(1)
    v_mfma_f32_16x16x32_bf16 v[16:19], v[192:195], v[8:11], v[16:19]
    ds_read_b128 v[4:7], v2 offset:12288
    v_mfma_f32_16x16x32_bf16 v[20:23], v[196:199], v[8:11], v[20:23]
    s_add_u32 s70, s68, s37
    v_mfma_f32_16x16x32_bf16 v[24:27], v[200:203], v[8:11], v[24:27]
    buffer_load_dwordx4 v2, s[48:51], s70 offen offset:2048 sc1 lds
    v_mfma_f32_16x16x32_bf16 v[28:31], v[204:207], v[8:11], v[28:31]
    s_waitcnt vmcnt(11) lgkmcnt(1)
    v_mfma_f32_16x16x32_bf16 v[16:19], v[208:211], v[12:15], v[16:19]
    ds_read_b128 v[8:11], v2 offset:13312
    v_mfma_f32_16x16x32_bf16 v[20:23], v[212:215], v[12:15], v[20:23]
    s_add_u32 s70, s68, s37
    v_mfma_f32_16x16x32_bf16 v[24:27], v[216:219], v[12:15], v[24:27]
    buffer_load_dwordx4 v2, s[48:51], s70 offen offset:3072 sc1 lds
    v_mfma_f32_16x16x32_bf16 v[28:31], v[220:223], v[12:15], v[28:31]
    s_waitcnt vmcnt(11) lgkmcnt(1)
    v_mfma_f32_16x16x32_bf16 v[16:19], a[0:3], v[4:7], v[16:19]
    ds_read_b128 v[12:15], v2 offset:0
    v_mfma_f32_16x16x32_bf16 v[20:23], a[4:7], v[4:7], v[20:23]
    s_add_u32 m0, s20, 12288
    s_add_u32 s70, s68, s38
    v_mfma_f32_16x16x32_bf16 v[24:27], a[8:11], v[4:7], v[24:27]
    buffer_load_dwordx4 v2, s[48:51], s70 offen offset:0 sc1 lds
    v_mfma_f32_16x16x32_bf16 v[28:31], a[12:15], v[4:7], v[28:31]
    s_waitcnt vmcnt(11) lgkmcnt(1)
    v_mfma_f32_16x16x32_bf16 v[16:19], a[16:19], v[8:11], v[16:19]
    ds_read_b128 v[4:7], v2 offset:1024
    v_mfma_f32_16x16x32_bf16 v[20:23], a[20:23], v[8:11], v[20:23]
    s_add_u32 s70, s68, s38
    v_mfma_f32_16x16x32_bf16 v[24:27], a[24:27], v[8:11], v[24:27]
    buffer_load_dwordx4 v2, s[48:51], s70 offen offset:1024 sc1 lds
    v_mfma_f32_16x16x32_bf16 v[28:31], a[28:31], v[8:11], v[28:31]
    s_waitcnt vmcnt(11) lgkmcnt(1)
    v_mov_b32 v0, 152064
    ds_read_b128 v[8:11], v0 offset:64
    s_waitcnt lgkmcnt(0)
LB_26:
    v_xor_b32 v8, s89, v8
    v_xor_b32 v9, s89, v9
    v_xor_b32 v10, s89, v10
    v_xor_b32 v11, s89, v11
    v_or3_b32 v9, v9, v10, v11
    v_or_b32 v8, v8, v9
    v_cmp_ne_u32 vcc, 0, v8
    s_nop 0
    s_cbranch_vccnz LS_25
LO_27:
    ds_write_b128 v1, v[16:19] offset:0
    v_xor_b32 v1, 64, v1
    v_mfma_f32_16x16x32_bf16 v[16:19], v[32:35], v[12:15], 0
    ds_write_b128 v1, v[20:23] offset:0
    v_xor_b32 v1, 192, v1
    v_mfma_f32_16x16x32_bf16 v[20:23], v[36:39], v[12:15], 0
    ds_write_b128 v1, v[24:27] offset:0
    v_xor_b32 v1, 64, v1
    s_mul_i32 s68, s66, 57344
    s_add_u32 m0, s20, 0
    s_add_u32 s70, s68, s32
    v_mfma_f32_16x16x32_bf16 v[24:27], v[40:43], v[12:15], 0
    ds_write_b128 v1, v[28:31] offset:0
    v_xor_b32 v1, 192, v1
    buffer_load_dwordx4 v2, s[48:51], s70 offen offset:0 sc1 lds
    v_mfma_f32_16x16x32_bf16 v[28:31], v[44:47], v[12:15], 0
    ds_read_b128 v[8:11], v2 offset:2048
    s_waitcnt vmcnt(11) lgkmcnt(6)
    v_mfma_f32_16x16x32_bf16 v[16:19], v[48:51], v[4:7], v[16:19]
    ds_read_b128 v[12:15], v2 offset:3072
    v_mfma_f32_16x16x32_bf16 v[20:23], v[52:55], v[4:7], v[20:23]
    s_add_u32 s70, s68, s32
    v_mfma_f32_16x16x32_bf16 v[24:27], v[56:59], v[4:7], v[24:27]
    buffer_load_dwordx4 v2, s[48:51], s70 offen offset:1024 sc1 lds
    v_mfma_f32_16x16x32_bf16 v[28:31], v[60:63], v[4:7], v[28:31]
    s_waitcnt lgkmcnt(0)
    s_barrier
    s_waitcnt vmcnt(11) lgkmcnt(1)
    v_mfma_f32_16x16x32_bf16 v[16:19], v[64:67], v[8:11], v[16:19]
    ds_read_b128 v[4:7], v2 offset:4096
    v_mfma_f32_16x16x32_bf16 v[20:23], v[68:71], v[8:11], v[20:23]
    s_add_u32 s70, s68, s32
    v_mfma_f32_16x16x32_bf16 v[24:27], v[72:75], v[8:11], v[24:27]
    buffer_load_dwordx4 v2, s[48:51], s70 offen offset:2048 sc1 lds
    v_mfma_f32_16x16x32_bf16 v[28:31], v[76:79], v[8:11], v[28:31]
    s_waitcnt vmcnt(11) lgkmcnt(1)
    v_mfma_f32_16x16x32_bf16 v[16:19], v[80:83], v[12:15], v[16:19]
    ds_read_b128 v[8:11], v2 offset:5120
    v_mfma_f32_16x16x32_bf16 v[20:23], v[84:87], v[12:15], v[20:23]
    s_add_u32 s70, s68, s33
    v_mfma_f32_16x16x32_bf16 v[24:27], v[88:91], v[12:15], v[24:27]
    buffer_load_dwordx4 v2, s[48:51], s70 offen offset:3072 sc1 lds
    v_mfma_f32_16x16x32_bf16 v[28:31], v[92:95], v[12:15], v[28:31]
    s_waitcnt vmcnt(11) lgkmcnt(1)
    v_mfma_f32_16x16x32_bf16 v[16:19], v[96:99], v[4:7], v[16:19]
    ds_read_b128 v[12:15], v2 offset:6144
    v_mfma_f32_16x16x32_bf16 v[20:23], v[100:103], v[4:7], v[20:23]
    s_add_u32 m0, s20, 4096
    s_add_u32 s70, s68, s34
    v_mfma_f32_16x16x32_bf16 v[24:27], v[104:107], v[4:7], v[24:27]
    buffer_load_dwordx4 v2, s[48:51], s70 offen offset:0 sc1 lds
    v_mfma_f32_16x16x32_bf16 v[28:31], v[108:111], v[4:7], v[28:31]
    s_waitcnt vmcnt(11) lgkmcnt(1)
    v_mfma_f32_16x16x32_bf16 v[16:19], v[112:115], v[8:11], v[16:19]
    ds_read_b128 v[4:7], v2 offset:7168
    v_mfma_f32_16x16x32_bf16 v[20:23], v[116:119], v[8:11], v[20:23]
    s_add_u32 s70, s68, s34
    v_mfma_f32_16x16x32_bf16 v[24:27], v[120:123], v[8:11], v[24:27]
    buffer_load_dwordx4 v2, s[48:51], s70 offen offset:1024 sc1 lds
    v_mfma_f32_16x16x32_bf16 v[28:31], v[124:127], v[8:11], v[28:31]
    s_waitcnt vmcnt(11) lgkmcnt(1)
    v_mfma_f32_16x16x32_bf16 v[16:19], v[128:131], v[12:15], v[16:19]
    ds_read_b128 v[8:11], v2 offset:8192
    v_mfma_f32_16x16x32_bf16 v[20:23], v[132:135], v[12:15], v[20:23]
    s_add_u32 s70, s68, s34
    v_mfma_f32_16x16x32_bf16 v[24:27], v[136:139], v[12:15], v[24:27]
    buffer_load_dwordx4 v2, s[48:51], s70 offen offset:2048 sc1 lds
    v_mfma_f32_16x16x32_bf16 v[28:31], v[140:143], v[12:15], v[28:31]
    s_waitcnt vmcnt(11) lgkmcnt(1)
    v_mfma_f32_16x16x32_bf16 v[16:19], v[144:147], v[4:7], v[16:19]
    ds_read_b128 v[12:15], v2 offset:9216
    v_mfma_f32_16x16x32_bf16 v[20:23], v[148:151], v[4:7], v[20:23]
    s_add_u32 s70, s68, s35
    v_mfma_f32_16x16x32_bf16 v[24:27], v[152:155], v[4:7], v[24:27]
    buffer_load_dwordx4 v2, s[48:51], s70 offen offset:3072 sc1 lds
    v_mfma_f32_16x16x32_bf16 v[28:31], v[156:159], v[4:7], v[28:31]
    s_waitcnt vmcnt(11) lgkmcnt(1)
    v_mfma_f32_16x16x32_bf16 v[16:19], v[160:163], v[8:11], v[16:19]
    ds_read_b128 v[4:7], v2 offset:10240
    v_mfma_f32_16x16x32_bf16 v[20:23], v[164:167], v[8:11], v[20:23]
    s_add_u32 m0, s20, 8192
    s_add_u32 s70, s68, s36
    v_mfma_f32_16x16x32_bf16 v[24:27], v[168:171], v[8:11], v[24:27]
    buffer_load_dwordx4 v2, s[48:51], s70 offen offset:0 sc1 lds
    v_mfma_f32_16x16x32_bf16 v[28:31], v[172:175], v[8:11], v[28:31]
    s_waitcnt vmcnt(11) lgkmcnt(1)
    v_mfma_f32_16x16x32_bf16 v[16:19], v[176:179], v[12:15], v[16:19]
    ds_read_b128 v[8:11], v2 offset:11264
    v_mfma_f32_16x16x32_bf16 v[20:23], v[180:183], v[12:15], v[20:23]
    s_add_u32 s70, s68, s36
    v_mfma_f32_16x16x32_bf16 v[24:27], v[184:187], v[12:15], v[24:27]
    buffer_load_dwordx4 v2, s[48:51], s70 offen offset:1024 sc1 lds
    v_mfma_f32_16x16x32_bf16 v[28:31], v[188:191], v[12:15], v[28:31]
    s_waitcnt vmcnt(11) lgkmcnt(1)
    v_mfma_f32_16x16x32_bf16 v[16:19], v[192:195], v[4:7], v[16:19]
    ds_read_b128 v[12:15], v2 offset:12288
    v_mfma_f32_16x16x32_bf16 v[20:23], v[196:199], v[4:7], v[20:23]
    s_add_u32 s70, s68, s37
    v_mfma_f32_16x16x32_bf16 v[24:27], v[200:203], v[4:7], v[24:27]
    buffer_load_dwordx4 v2, s[48:51], s70 offen offset:2048 sc1 lds
    v_mfma_f32_16x16x32_bf16 v[28:31], v[204:207], v[4:7], v[28:31]
    s_waitcnt vmcnt(11) lgkmcnt(1)
    v_mfma_f32_16x16x32_bf16 v[16:19], v[208:211], v[8:11], v[16:19]
    ds_read_b128 v[4:7], v2 offset:13312
    v_mfma_f32_16x16x32_bf16 v[20:23], v[212:215], v[8:11], v[20:23]
    s_add_u32 s70, s68, s37
    v_mfma_f32_16x16x32_bf16 v[24:27], v[216:219], v[8:11], v[24:27]
    buffer_load_dwordx4 v2, s[48:51], s70 offen offset:3072 sc1 lds
    v_mfma_f32_16x16x32_bf16 v[28:31], v[220:223], v[8:11], v[28:31]
    s_waitcnt vmcnt(11) lgkmcnt(1)
    v_mfma_f32_16x16x32_bf16 v[16:19], a[0:3], v[12:15], v[16:19]
    ds_read_b128 v[8:11], v2 offset:0
    v_mfma_f32_16x16x32_bf16 v[20:23], a[4:7], v[12:15], v[20:23]
    s_add_u32 m0, s20, 12288
    s_add_u32 s70, s68, s38
    v_mfma_f32_16x16x32_bf16 v[24:27], a[8:11], v[12:15], v[24:27]
    buffer_load_dwordx4 v2, s[48:51], s70 offen offset:0 sc1 lds
    v_mfma_f32_16x16x32_bf16 v[28:31], a[12:15], v[12:15], v[28:31]
    s_waitcnt vmcnt(11) lgkmcnt(1)
    v_mfma_f32_16x16x32_bf16 v[16:19], a[16:19], v[4:7], v[16:19]
    ds_read_b128 v[12:15], v2 offset:1024
    v_mfma_f32_16x16x32_bf16 v[20:23], a[20:23], v[4:7], v[20:23]
    s_add_u32 s70, s68, s38
    v_mfma_f32_16x16x32_bf16 v[24:27], a[24:27], v[4:7], v[24:27]
    buffer_load_dwordx4 v2, s[48:51], s70 offen offset:1024 sc1 lds
    v_mfma_f32_16x16x32_bf16 v[28:31], a[28:31], v[4:7], v[28:31]
    s_waitcnt vmcnt(11) lgkmcnt(1)
    s_nop 4
    ds_write_b128 v1, v[16:19] offset:16384
    v_xor_b32 v1, 64, v1
    v_mfma_f32_16x16x32_bf16 v[16:19], v[32:35], v[8:11], 0
    ds_write_b128 v1, v[20:23] offset:16384
    v_xor_b32 v1, 192, v1
    v_mfma_f32_16x16x32_bf16 v[20:23], v[36:39], v[8:11], 0
    ds_write_b128 v1, v[24:27] offset:16384
    v_xor_b32 v1, 64, v1
    s_mul_i32 s68, s67, 57344
    s_add_u32 m0, s20, 0
    s_add_u32 s70, s68, s32
    v_mfma_f32_16x16x32_bf16 v[24:27], v[40:43], v[8:11], 0
    ds_write_b128 v1, v[28:31] offset:16384
    v_xor_b32 v1, 192, v1
    buffer_load_dwordx4 v2, s[48:51], s70 offen offset:0 sc1 lds
    v_mfma_f32_16x16x32_bf16 v[28:31], v[44:47], v[8:11], 0
    ds_read_b128 v[4:7], v2 offset:2048
    s_waitcnt vmcnt(11) lgkmcnt(5)
    v_mfma_f32_16x16x32_bf16 v[16:19], v[48:51], v[12:15], v[16:19]
    ds_read_b128 v[8:11], v2 offset:3072
    v_mfma_f32_16x16x32_bf16 v[20:23], v[52:55], v[12:15], v[20:23]
    s_add_u32 s70, s68, s32
    v_mfma_f32_16x16x32_bf16 v[24:27], v[56:59], v[12:15], v[24:27]
    buffer_load_dwordx4 v2, s[48:51], s70 offen offset:1024 sc1 lds
    v_mfma_f32_16x16x32_bf16 v[28:31], v[60:63], v[12:15], v[28:31]
    s_waitcnt lgkmcnt(0)
    s_barrier
    s_waitcnt vmcnt(11) lgkmcnt(1)
    v_mfma_f32_16x16x32_bf16 v[16:19], v[64:67], v[4:7], v[16:19]
    ds_read_b128 v[12:15], v2 offset:4096
    v_mfma_f32_16x16x32_bf16 v[20:23], v[68:71], v[4:7], v[20:23]
    s_add_u32 s70, s68, s32
    v_mfma_f32_16x16x32_bf16 v[24:27], v[72:75], v[4:7], v[24:27]
    buffer_load_dwordx4 v2, s[48:51], s70 offen offset:2048 sc1 lds
    v_mfma_f32_16x16x32_bf16 v[28:31], v[76:79], v[4:7], v[28:31]
    s_waitcnt vmcnt(11) lgkmcnt(1)
    v_mfma_f32_16x16x32_bf16 v[16:19], v[80:83], v[8:11], v[16:19]
    ds_read_b128 v[4:7], v2 offset:5120
    v_mfma_f32_16x16x32_bf16 v[20:23], v[84:87], v[8:11], v[20:23]
    s_add_u32 s70, s68, s33
    v_mfma_f32_16x16x32_bf16 v[24:27], v[88:91], v[8:11], v[24:27]
    buffer_load_dwordx4 v2, s[48:51], s70 offen offset:3072 sc1 lds
    v_mfma_f32_16x16x32_bf16 v[28:31], v[92:95], v[8:11], v[28:31]
    s_waitcnt vmcnt(11) lgkmcnt(1)
    v_mfma_f32_16x16x32_bf16 v[16:19], v[96:99], v[12:15], v[16:19]
    ds_read_b128 v[8:11], v2 offset:6144
    v_mfma_f32_16x16x32_bf16 v[20:23], v[100:103], v[12:15], v[20:23]
    s_add_u32 m0, s20, 4096
    s_add_u32 s70, s68, s34
    v_mfma_f32_16x16x32_bf16 v[24:27], v[104:107], v[12:15], v[24:27]
    buffer_load_dwordx4 v2, s[48:51], s70 offen offset:0 sc1 lds
    v_mfma_f32_16x16x32_bf16 v[28:31], v[108:111], v[12:15], v[28:31]
    s_waitcnt vmcnt(11) lgkmcnt(1)
    v_mfma_f32_16x16x32_bf16 v[16:19], v[112:115], v[4:7], v[16:19]
    ds_read_b128 v[12:15], v2 offset:7168
    v_mfma_f32_16x16x32_bf16 v[20:23], v[116:119], v[4:7], v[20:23]
    s_add_u32 s70, s68, s34
    v_mfma_f32_16x16x32_bf16 v[24:27], v[120:123], v[4:7], v[24:27]
    buffer_load_dwordx4 v2, s[48:51], s70 offen offset:1024 sc1 lds
    v_mfma_f32_16x16x32_bf16 v[28:31], v[124:127], v[4:7], v[28:31]
    s_waitcnt vmcnt(11) lgkmcnt(1)
    v_mfma_f32_16x16x32_bf16 v[16:19], v[128:131], v[8:11], v[16:19]
    ds_read_b128 v[4:7], v2 offset:8192
    v_mfma_f32_16x16x32_bf16 v[20:23], v[132:135], v[8:11], v[20:23]
    s_add_u32 s70, s68, s34
    v_mfma_f32_16x16x32_bf16 v[24:27], v[136:139], v[8:11], v[24:27]
    buffer_load_dwordx4 v2, s[48:51], s70 offen offset:2048 sc1 lds
    v_mfma_f32_16x16x32_bf16 v[28:31], v[140:143], v[8:11], v[28:31]
    s_waitcnt vmcnt(11) lgkmcnt(1)
    v_mfma_f32_16x16x32_bf16 v[16:19], v[144:147], v[12:15], v[16:19]
    ds_read_b128 v[8:11], v2 offset:9216
    v_mfma_f32_16x16x32_bf16 v[20:23], v[148:151], v[12:15], v[20:23]
    s_add_u32 s70, s68, s35
    v_mfma_f32_16x16x32_bf16 v[24:27], v[152:155], v[12:15], v[24:27]
    buffer_load_dwordx4 v2, s[48:51], s70 offen offset:3072 sc1 lds
    v_mfma_f32_16x16x32_bf16 v[28:31], v[156:159], v[12:15], v[28:31]
    s_waitcnt vmcnt(11) lgkmcnt(1)
    v_mfma_f32_16x16x32_bf16 v[16:19], v[160:163], v[4:7], v[16:19]
    ds_read_b128 v[12:15], v2 offset:10240
    v_mfma_f32_16x16x32_bf16 v[20:23], v[164:167], v[4:7], v[20:23]
    s_add_u32 m0, s20, 8192
    s_add_u32 s70, s68, s36
    v_mfma_f32_16x16x32_bf16 v[24:27], v[168:171], v[4:7], v[24:27]
    buffer_load_dwordx4 v2, s[48:51], s70 offen offset:0 sc1 lds
    v_mfma_f32_16x16x32_bf16 v[28:31], v[172:175], v[4:7], v[28:31]
    s_waitcnt vmcnt(11) lgkmcnt(1)
    v_mfma_f32_16x16x32_bf16 v[16:19], v[176:179], v[8:11], v[16:19]
    ds_read_b128 v[4:7], v2 offset:11264
    v_mfma_f32_16x16x32_bf16 v[20:23], v[180:183], v[8:11], v[20:23]
    s_add_u32 s70, s68, s36
    v_mfma_f32_16x16x32_bf16 v[24:27], v[184:187], v[8:11], v[24:27]
    buffer_load_dwordx4 v2, s[48:51], s70 offen offset:1024 sc1 lds
    v_mfma_f32_16x16x32_bf16 v[28:31], v[188:191], v[8:11], v[28:31]
    s_waitcnt vmcnt(11) lgkmcnt(1)
    v_mfma_f32_16x16x32_bf16 v[16:19], v[192:195], v[12:15], v[16:19]
    ds_read_b128 v[8:11], v2 offset:12288
    v_mfma_f32_16x16x32_bf16 v[20:23], v[196:199], v[12:15], v[20:23]
    s_add_u32 s70, s68, s37
    v_mfma_f32_16x16x32_bf16 v[24:27], v[200:203], v[12:15], v[24:27]
    buffer_load_dwordx4 v2, s[48:51], s70 offen offset:2048 sc1 lds
    v_mfma_f32_16x16x32_bf16 v[28:31], v[204:207], v[12:15], v[28:31]
    s_waitcnt vmcnt(11) lgkmcnt(1)
    v_mfma_f32_16x16x32_bf16 v[16:19], v[208:211], v[4:7], v[16:19]
    ds_read_b128 v[12:15], v2 offset:13312
    v_mfma_f32_16x16x32_bf16 v[20:23], v[212:215], v[4:7], v[20:23]
    s_add_u32 s70, s68, s37
    v_mfma_f32_16x16x32_bf16 v[24:27], v[216:219], v[4:7], v[24:27]
    buffer_load_dwordx4 v2, s[48:51], s70 offen offset:3072 sc1 lds
    v_mfma_f32_16x16x32_bf16 v[28:31], v[220:223], v[4:7], v[28:31]
    s_waitcnt vmcnt(11) lgkmcnt(1)
    v_mfma_f32_16x16x32_bf16 v[16:19], a[0:3], v[8:11], v[16:19]
    ds_read_b128 v[4:7], v2 offset:0
    v_mfma_f32_16x16x32_bf16 v[20:23], a[4:7], v[8:11], v[20:23]
    s_add_u32 m0, s20, 12288
    s_add_u32 s70, s68, s38
    v_mfma_f32_16x16x32_bf16 v[24:27], a[8:11], v[8:11], v[24:27]
    buffer_load_dwordx4 v2, s[48:51], s70 offen offset:0 sc1 lds
    v_mfma_f32_16x16x32_bf16 v[28:31], a[12:15], v[8:11], v[28:31]
    s_waitcnt vmcnt(11) lgkmcnt(1)
    v_mfma_f32_16x16x32_bf16 v[16:19], a[16:19], v[12:15], v[16:19]
    ds_read_b128 v[8:11], v2 offset:1024
    v_mfma_f32_16x16x32_bf16 v[20:23], a[20:23], v[12:15], v[20:23]
    s_add_u32 s70, s68, s38
    v_mfma_f32_16x16x32_bf16 v[24:27], a[24:27], v[12:15], v[24:27]
    buffer_load_dwordx4 v2, s[48:51], s70 offen offset:1024 sc1 lds
    v_mfma_f32_16x16x32_bf16 v[28:31], a[28:31], v[12:15], v[28:31]
    s_waitcnt vmcnt(11) lgkmcnt(1)
    s_nop 4
    ds_write_b128 v1, v[16:19] offset:0
    v_xor_b32 v1, 64, v1
    v_mfma_f32_16x16x32_bf16 v[16:19], v[32:35], v[4:7], 0
    ds_write_b128 v1, v[20:23] offset:0
    v_xor_b32 v1, 192, v1
    v_mfma_f32_16x16x32_bf16 v[20:23], v[36:39], v[4:7], 0
    ds_write_b128 v1, v[24:27] offset:0
    v_xor_b32 v1, 64, v1
    v_mfma_f32_16x16x32_bf16 v[24:27], v[40:43], v[4:7], 0
    ds_write_b128 v1, v[28:31] offset:0
    v_xor_b32 v1, 192, v1
    v_mfma_f32_16x16x32_bf16 v[28:31], v[44:47], v[4:7], 0
    ds_read_b128 v[12:15], v2 offset:2048
    s_waitcnt vmcnt(10) lgkmcnt(5)
    v_mfma_f32_16x16x32_bf16 v[16:19], v[48:51], v[8:11], v[16:19]
    ds_read_b128 v[4:7], v2 offset:3072
    v_mfma_f32_16x16x32_bf16 v[20:23], v[52:55], v[8:11], v[20:23]
    v_mfma_f32_16x16x32_bf16 v[24:27], v[56:59], v[8:11], v[24:27]
    v_mfma_f32_16x16x32_bf16 v[28:31], v[60:63], v[8:11], v[28:31]
    s_waitcnt lgkmcnt(0)
    s_barrier
    s_waitcnt vmcnt(9) lgkmcnt(1)
    v_mfma_f32_16x16x32_bf16 v[16:19], v[64:67], v[12:15], v[16:19]
    ds_read_b128 v[8:11], v2 offset:4096
    v_mfma_f32_16x16x32_bf16 v[20:23], v[68:71], v[12:15], v[20:23]
    v_mfma_f32_16x16x32_bf16 v[24:27], v[72:75], v[12:15], v[24:27]
    v_mfma_f32_16x16x32_bf16 v[28:31], v[76:79], v[12:15], v[28:31]
    s_waitcnt vmcnt(8) lgkmcnt(1)
    v_mfma_f32_16x16x32_bf16 v[16:19], v[80:83], v[4:7], v[16:19]
    ds_read_b128 v[12:15], v2 offset:5120
    v_mfma_f32_16x16x32_bf16 v[20:23], v[84:87], v[4:7], v[20:23]
    v_mfma_f32_16x16x32_bf16 v[24:27], v[88:91], v[4:7], v[24:27]
    v_mfma_f32_16x16x32_bf16 v[28:31], v[92:95], v[4:7], v[28:31]
    s_waitcnt vmcnt(7) lgkmcnt(1)
    v_mfma_f32_16x16x32_bf16 v[16:19], v[96:99], v[8:11], v[16:19]
    ds_read_b128 v[4:7], v2 offset:6144
    v_mfma_f32_16x16x32_bf16 v[20:23], v[100:103], v[8:11], v[20:23]
    v_mfma_f32_16x16x32_bf16 v[24:27], v[104:107], v[8:11], v[24:27]
    v_mfma_f32_16x16x32_bf16 v[28:31], v[108:111], v[8:11], v[28:31]
    s_waitcnt vmcnt(6) lgkmcnt(1)
    v_mfma_f32_16x16x32_bf16 v[16:19], v[112:115], v[12:15], v[16:19]
    ds_read_b128 v[8:11], v2 offset:7168
    v_mfma_f32_16x16x32_bf16 v[20:23], v[116:119], v[12:15], v[20:23]
    v_mfma_f32_16x16x32_bf16 v[24:27], v[120:123], v[12:15], v[24:27]
    v_mfma_f32_16x16x32_bf16 v[28:31], v[124:127], v[12:15], v[28:31]
    s_waitcnt vmcnt(5) lgkmcnt(1)
    v_mfma_f32_16x16x32_bf16 v[16:19], v[128:131], v[4:7], v[16:19]
    ds_read_b128 v[12:15], v2 offset:8192
    v_mfma_f32_16x16x32_bf16 v[20:23], v[132:135], v[4:7], v[20:23]
    v_mfma_f32_16x16x32_bf16 v[24:27], v[136:139], v[4:7], v[24:27]
    v_mfma_f32_16x16x32_bf16 v[28:31], v[140:143], v[4:7], v[28:31]
    s_waitcnt vmcnt(4) lgkmcnt(1)
    v_mfma_f32_16x16x32_bf16 v[16:19], v[144:147], v[8:11], v[16:19]
    ds_read_b128 v[4:7], v2 offset:9216
    v_mfma_f32_16x16x32_bf16 v[20:23], v[148:151], v[8:11], v[20:23]
    v_mfma_f32_16x16x32_bf16 v[24:27], v[152:155], v[8:11], v[24:27]
    v_mfma_f32_16x16x32_bf16 v[28:31], v[156:159], v[8:11], v[28:31]
    s_waitcnt vmcnt(3) lgkmcnt(1)
    v_mfma_f32_16x16x32_bf16 v[16:19], v[160:163], v[12:15], v[16:19]
    ds_read_b128 v[8:11], v2 offset:10240
    v_mfma_f32_16x16x32_bf16 v[20:23], v[164:167], v[12:15], v[20:23]
    v_mfma_f32_16x16x32_bf16 v[24:27], v[168:171], v[12:15], v[24:27]
    v_mfma_f32_16x16x32_bf16 v[28:31], v[172:175], v[12:15], v[28:31]
    s_waitcnt vmcnt(2) lgkmcnt(1)
    v_mfma_f32_16x16x32_bf16 v[16:19], v[176:179], v[4:7], v[16:19]
    ds_read_b128 v[12:15], v2 offset:11264
    v_mfma_f32_16x16x32_bf16 v[20:23], v[180:183], v[4:7], v[20:23]
    v_mfma_f32_16x16x32_bf16 v[24:27], v[184:187], v[4:7], v[24:27]
    v_mfma_f32_16x16x32_bf16 v[28:31], v[188:191], v[4:7], v[28:31]
    s_waitcnt vmcnt(1) lgkmcnt(1)
    v_mfma_f32_16x16x32_bf16 v[16:19], v[192:195], v[8:11], v[16:19]
    ds_read_b128 v[4:7], v2 offset:12288
    v_mfma_f32_16x16x32_bf16 v[20:23], v[196:199], v[8:11], v[20:23]
    v_mfma_f32_16x16x32_bf16 v[24:27], v[200:203], v[8:11], v[24:27]
    v_mfma_f32_16x16x32_bf16 v[28:31], v[204:207], v[8:11], v[28:31]
    s_waitcnt vmcnt(0) lgkmcnt(1)
    v_mfma_f32_16x16x32_bf16 v[16:19], v[208:211], v[12:15], v[16:19]
    ds_read_b128 v[8:11], v2 offset:13312
    v_mfma_f32_16x16x32_bf16 v[20:23], v[212:215], v[12:15], v[20:23]
    v_mfma_f32_16x16x32_bf16 v[24:27], v[216:219], v[12:15], v[24:27]
    v_mfma_f32_16x16x32_bf16 v[28:31], v[220:223], v[12:15], v[28:31]
    s_waitcnt lgkmcnt(1)
    v_mfma_f32_16x16x32_bf16 v[16:19], a[0:3], v[4:7], v[16:19]
    v_mfma_f32_16x16x32_bf16 v[20:23], a[4:7], v[4:7], v[20:23]
    v_mfma_f32_16x16x32_bf16 v[24:27], a[8:11], v[4:7], v[24:27]
    v_mfma_f32_16x16x32_bf16 v[28:31], a[12:15], v[4:7], v[28:31]
    s_waitcnt lgkmcnt(0)
    v_mfma_f32_16x16x32_bf16 v[16:19], a[16:19], v[8:11], v[16:19]
    v_mfma_f32_16x16x32_bf16 v[20:23], a[20:23], v[8:11], v[20:23]
    v_mfma_f32_16x16x32_bf16 v[24:27], a[24:27], v[8:11], v[24:27]
    v_mfma_f32_16x16x32_bf16 v[28:31], a[28:31], v[8:11], v[28:31]
    s_nop 4
    ds_write_b128 v1, v[16:19] offset:16384
    v_xor_b32 v1, 64, v1
    ds_write_b128 v1, v[20:23] offset:16384
    v_xor_b32 v1, 192, v1
    ds_write_b128 v1, v[24:27] offset:16384
    v_xor_b32 v1, 64, v1
    ds_write_b128 v1, v[28:31] offset:16384
    v_xor_b32 v1, 192, v1
    s_waitcnt lgkmcnt(0)
    s_barrier
    s_endpgm
L_A:
    s_sub_u32 s92, s2, 32
    s_and_b32 s93, s92, 7
    s_lshr_b32 s92, s92, 3
    s_mul_i32 s94, s92, 37
    s_lshr_b32 s94, s94, 8
    s_lshr_b32 s87, s93, 1
    s_lshl_b32 s85, s87, 2
    s_add_u32 s83, s85, s94
    s_lshl_b32 s87, s87, 1
    s_mul_i32 s94, s94, 7
    s_sub_u32 s92, s92, s94
    s_and_b32 s84, s93, 1
    s_mul_i32 s84, s84, 7
    s_add_u32 s84, s84, s92
    v_lshlrev_b32 v24, 4, v1
    v_lshrrev_b32 v27, 4, v1
    v_bfe_u32 v28, v1, 2, 2
    v_and_b32 v29, 1, v27
    v_lshl_or_b32 v29, v29, 2, v28
    v_lshlrev_b32 v30, 12, v27
    v_lshl_or_b32 v30, v28, 8, v30
    v_and_b32 v28, 3, v1
    v_lshl_or_b32 v30, v28, 3, v30
    s_lshl_b32 s92, s82, 2
    v_xor_b32 v29, s92, v29
    v_xor_b32 v28, 0, v29
    v_lshl_add_u32 v2, v28, 5, v30
    v_xor_b32 v28, 1, v29
    v_lshl_add_u32 v3, v28, 5, v30
    v_xor_b32 v28, 2, v29
    v_lshl_add_u32 v4, v28, 5, v30
    v_xor_b32 v28, 3, v29
    v_lshl_add_u32 v5, v28, 5, v30
    v_and_b32 v28, 15, v1
    v_lshrrev_b32 v29, 1, v28
    v_xor_b32 v29, v29, v27
    s_lshl_b32 s92, s81, 13
    s_add_u32 s92, s92, 65536
    v_lshlrev_b32 v28, 7, v28
    v_lshl_or_b32 v28, v29, 4, v28
    v_add_u32 v6, s92, v28
    v_xor_b32 v7, 64, v6
    s_waitcnt lgkmcnt(0)
    s_and_b32 s92, s2, 7
    s_lshr_b32 s93, s2, 3
    s_and_b32 s91, s93, 7
    s_lshr_b32 s93, s93, 3
    s_lshl_b32 s90, s92, 2
    s_add_u32 s90, s90, s93
    s_lshl_b32 s30, s2, 1
    s_add_u32 s30, s30, s81
    s_mov_b32 s48, s28
    s_and_b32 s49, s29, 0xffff
    s_mov_b32 s50, 268435456
    s_mov_b32 s51, 0x00020000
    s_mov_b32 s60, s26
    s_and_b32 s61, s27, 0xffff
    s_mov_b32 s62, 256
    s_mov_b32 s63, 0x00020000
    s_lshl_b32 s92, s2, 2
    s_load_dword s97, s[14:15], s92
    s_lshl_b32 s92, s83, 1
    s_add_u32 s92, s92, s81
    s_lshl_b32 s93, s92, 12
    s_lshl_b32 s3, s84, 8
    s_add_u32 s3, s3, s93
    s_lshl_b32 s93, s82, 7
    s_add_u32 s3, s3, s93
    s_add_u32 s3, s3, 393216
    s_mul_i32 s92, s92, 224
    s_lshl_b32 s93, s84, 2
    s_add_u32 s92, s92, s93
    s_lshl_b32 s93, s82, 1
    s_add_u32 s92, s92, s93
    s_lshl_b32 s92, s92, 10
    s_add_u32 s37, s92, 8388608
    v_and_b32 v27, 15, v1
    v_lshrrev_b32 v28, 4, v1
    v_and_b32 v29, 7, v27
    v_lshrrev_b32 v30, 1, v29
    v_and_b32 v29, 1, v29
    v_lshl_add_u32 v29, v30, 2, v29
    v_min_u32 v29, 12, v29
    v_add_u32 v30, 1, v27
    v_lshrrev_b32 v26, 3, v30
    v_and_b32 v30, 7, v30
    v_add3_u32 v29, v29, v26, v28
    v_lshlrev_b32 v29, 4, v29
    v_and_b32 v25, 1, v30
    v_mul_u32_u24 v25, 114688, v25
    v_lshrrev_b32 v30, 1, v30
    v_mul_u32_u24 v30, 4352, v30
    v_add_u32 v29, v29, v25
    s_mul_i32 s93, s81, 17408
    s_lshl_b32 s92, s82, 8
    s_add_u32 s93, s93, s92
    v_add3_u32 v25, v29, v30, s93
    v_lshlrev_b32 v29, 5, v27
    v_lshlrev_b32 v30, 4, v28
    v_sub_u32 v29, v30, v29
    s_mul_i32 s93, s81, 4608
    s_add_u32 s93, s93, s92
    s_add_u32 s93, s93, 35296
    v_add_u32 v26, s93, v29
    v_mov_b32 v0, 152064
    s_and_b32 s64, s91, 3
    s_xor_b32 s65, s64, 1
    s_xor_b32 s66, s64, 2
    s_xor_b32 s67, s64, 3
    s_mov_b32 s56, s24
    s_and_b32 s57, s25, 0xffff
    s_mov_b32 s58, 2097152
    s_mov_b32 s59, 0x00020000
    s_mov_b32 s32, s4
    s_and_b32 s33, s5, 0xffff
    s_mov_b32 s34, 2097152
    s_mov_b32 s35, 0x00020000
    s_mov_b32 s101, 0xbfb8aa3b
    s_lshl_b32 s72, s90, 16
    s_add_u32 s72, s72, s95
    s_lshl_b32 s93, s91, 7
    s_add_u32 s72, s72, s93
    s_lshl_b32 s68, s64, 14
    s_add_u32 s68, s68, s72
    s_lshl_b32 s69, s65, 14
    s_add_u32 s69, s69, s72
    s_lshl_b32 s70, s66, 14
    s_add_u32 s70, s70, s72
    s_lshl_b32 s71, s67, 14
    s_add_u32 s71, s71, s72
    s_lshl_b32 s73, s90, 10
    s_lshl_b32 s93, s80, 6
    s_add_u32 s73, s73, s93
    s_add_u32 s73, s73, 65536
    s_lshl_b32 s74, s90, 3
    s_add_u32 s74, s74, 20480
    s_lshl_b32 s75, s91, 18
    s_lshl_b32 s93, s80, 16
    s_add_u32 s75, s75, s93
    s_lshl_b32 s93, s90, 7
    s_add_u32 s75, s75, s93
    s_add_u32 s75, s75, 4194304
    s_add_u32 s76, s75, 31744
    s_lshl_b32 s93, s82, 11
    s_lshl_b32 s77, s30, 12
    s_add_u32 s77, s77, s93
    s_add_u32 s77, s77, 4194304
    s_lshl_b32 s78, s30, 2
    s_add_u32 s78, s78, s93
    s_add_u32 s78, s78, 16384
    s_lshr_b32 s79, s90, 4
    s_lshl_b32 s79, s79, 11
    s_lshl_b32 s93, s91, 8
    s_add_u32 s79, s79, s93
    s_add_u32 s79, s79, 16384
    s_lshl_b32 s36, s80, 11
    s_setprio 1
    s_waitcnt lgkmcnt(0)
    s_barrier
    ds_read_b64_tr_b16 v[32:33], v2 offset:0
    ds_read_b64_tr_b16 v[34:35], v2 offset:1024
    ds_read_b64_tr_b16 v[36:37], v3 offset:0
    ds_read_b64_tr_b16 v[38:39], v3 offset:1024
    ds_read_b128 a[0:3], v6 offset:0
    ds_read_b64_tr_b16 v[40:41], v4 offset:0
    ds_read_b64_tr_b16 v[42:43], v4 offset:1024
    ds_read_b64_tr_b16 v[44:45], v5 offset:0
    ds_read_b64_tr_b16 v[46:47], v5 offset:1024
    ds_read_b128 a[4:7], v6 offset:2048
    ds_read_b64_tr_b16 v[48:49], v2 offset:2048
    ds_read_b64_tr_b16 v[50:51], v2 offset:3072
    ds_read_b64_tr_b16 v[52:53], v3 offset:2048
    ds_read_b64_tr_b16 v[54:55], v3 offset:3072
    ds_read_b128 a[8:11], v6 offset:4096
    ds_read_b64_tr_b16 v[56:57], v4 offset:2048
    ds_read_b64_tr_b16 v[58:59], v4 offset:3072
    ds_read_b64_tr_b16 v[60:61], v5 offset:2048
    ds_read_b64_tr_b16 v[62:63], v5 offset:3072
    ds_read_b128 a[12:15], v6 offset:6144
    s_waitcnt lgkmcnt(0)
    s_barrier
    v_mfma_f32_16x16x32_bf16 v[96:99], v[32:35], a[0:3], 0
    ds_read_b64_tr_b16 v[64:65], v2 offset:16384
    v_mfma_f32_16x16x32_bf16 v[100:103], v[32:35], a[4:7], 0
    ds_read_b64_tr_b16 v[66:67], v2 offset:17408
    v_mfma_f32_16x16x32_bf16 v[104:107], v[32:35], a[8:11], 0
    ds_read_b64_tr_b16 v[68:69], v3 offset:16384
    v_mfma_f32_16x16x32_bf16 v[108:111], v[32:35], a[12:15], 0
    ds_read_b64_tr_b16 v[70:71], v3 offset:17408
    v_mfma_f32_16x16x32_bf16 v[112:115], v[36:39], a[0:3], 0
    ds_read_b128 a[16:19], v7 offset:0
    v_mfma_f32_16x16x32_bf16 v[116:119], v[36:39], a[4:7], 0
    ds_read_b64_tr_b16 v[72:73], v4 offset:16384
    v_mfma_f32_16x16x32_bf16 v[120:123], v[36:39], a[8:11], 0
    ds_read_b64_tr_b16 v[74:75], v4 offset:17408
    v_mfma_f32_16x16x32_bf16 v[124:127], v[36:39], a[12:15], 0
    ds_read_b64_tr_b16 v[76:77], v5 offset:16384
    v_mfma_f32_16x16x32_bf16 v[128:131], v[40:43], a[0:3], 0
    ds_read_b64_tr_b16 v[78:79], v5 offset:17408
    v_mfma_f32_16x16x32_bf16 v[132:135], v[40:43], a[4:7], 0
    ds_read_b128 a[20:23], v7 offset:2048
    v_mfma_f32_16x16x32_bf16 v[136:139], v[40:43], a[8:11], 0
    ds_read_b64_tr_b16 v[80:81], v2 offset:18432
    v_mfma_f32_16x16x32_bf16 v[140:143], v[40:43], a[12:15], 0
    ds_read_b64_tr_b16 v[82:83], v2 offset:19456
    v_mfma_f32_16x16x32_bf16 v[144:147], v[44:47], a[0:3], 0
    ds_read_b64_tr_b16 v[84:85], v3 offset:18432
    v_mfma_f32_16x16x32_bf16 v[148:151], v[44:47], a[4:7], 0
    ds_read_b64_tr_b16 v[86:87], v3 offset:19456
    v_mfma_f32_16x16x32_bf16 v[152:155], v[44:47], a[8:11], 0
    ds_read_b128 a[24:27], v7 offset:4096
    v_mfma_f32_16x16x32_bf16 v[156:159], v[44:47], a[12:15], 0
    ds_read_b64_tr_b16 v[88:89], v4 offset:18432
    v_mfma_f32_16x16x32_bf16 v[160:163], v[48:51], a[0:3], 0
    ds_read_b64_tr_b16 v[90:91], v4 offset:19456
    v_mfma_f32_16x16x32_bf16 v[164:167], v[48:51], a[4:7], 0
    ds_read_b64_tr_b16 v[92:93], v5 offset:18432
    v_mfma_f32_16x16x32_bf16 v[168:171], v[48:51], a[8:11], 0
    ds_read_b64_tr_b16 v[94:95], v5 offset:19456
    v_mfma_f32_16x16x32_bf16 v[172:175], v[48:51], a[12:15], 0
    ds_read_b128 a[28:31], v7 offset:6144
    v_mfma_f32_16x16x32_bf16 v[176:179], v[52:55], a[0:3], 0
    v_mfma_f32_16x16x32_bf16 v[180:183], v[52:55], a[4:7], 0
    v_mfma_f32_16x16x32_bf16 v[184:187], v[52:55], a[8:11], 0
    v_mfma_f32_16x16x32_bf16 v[188:191], v[52:55], a[12:15], 0
    v_mfma_f32_16x16x32_bf16 v[192:195], v[56:59], a[0:3], 0
    v_mfma_f32_16x16x32_bf16 v[196:199], v[56:59], a[4:7], 0
    v_mfma_f32_16x16x32_bf16 v[200:203], v[56:59], a[8:11], 0
    v_mfma_f32_16x16x32_bf16 v[204:207], v[56:59], a[12:15], 0
    s_waitcnt lgkmcnt(0)
    s_barrier
    v_mfma_f32_16x16x32_bf16 v[208:211], v[60:63], a[0:3], 0
    ds_read_b64_tr_b16 v[32:33], v2 offset:32768
    v_mfma_f32_16x16x32_bf16 v[212:215], v[60:63], a[4:7], 0
    ds_read_b64_tr_b16 v[34:35], v2 offset:33792
    v_mfma_f32_16x16x32_bf16 v[216:219], v[60:63], a[8:11], 0
    ds_read_b64_tr_b16 v[36:37], v3 offset:32768
    v_mfma_f32_16x16x32_bf16 v[220:223], v[60:63], a[12:15], 0
    ds_read_b64_tr_b16 v[38:39], v3 offset:33792
    v_mfma_f32_16x16x32_bf16 v[96:99], v[64:67], a[16:19], v[96:99]
    ds_read_b128 a[0:3], v6 offset:16384
    v_mfma_f32_16x16x32_bf16 v[100:103], v[64:67], a[20:23], v[100:103]
    ds_read_b64_tr_b16 v[40:41], v4 offset:32768
    v_mfma_f32_16x16x32_bf16 v[104:107], v[64:67], a[24:27], v[104:107]
    ds_read_b64_tr_b16 v[42:43], v4 offset:33792
    v_mfma_f32_16x16x32_bf16 v[108:111], v[64:67], a[28:31], v[108:111]
    ds_read_b64_tr_b16 v[44:45], v5 offset:32768
    v_mfma_f32_16x16x32_bf16 v[112:115], v[68:71], a[16:19], v[112:115]
    ds_read_b64_tr_b16 v[46:47], v5 offset:33792
    v_mfma_f32_16x16x32_bf16 v[116:119], v[68:71], a[20:23], v[116:119]
    ds_read_b128 a[4:7], v6 offset:18432
    v_mfma_f32_16x16x32_bf16 v[120:123], v[68:71], a[24:27], v[120:123]
    ds_read_b64_tr_b16 v[48:49], v2 offset:34816
    v_mfma_f32_16x16x32_bf16 v[124:127], v[68:71], a[28:31], v[124:127]
    ds_read_b64_tr_b16 v[50:51], v2 offset:35840
    v_mfma_f32_16x16x32_bf16 v[128:131], v[72:75], a[16:19], v[128:131]
    ds_read_b64_tr_b16 v[52:53], v3 offset:34816
    v_mfma_f32_16x16x32_bf16 v[132:135], v[72:75], a[20:23], v[132:135]
    ds_read_b64_tr_b16 v[54:55], v3 offset:35840
    v_mfma_f32_16x16x32_bf16 v[136:139], v[72:75], a[24:27], v[136:139]
    ds_read_b128 a[8:11], v6 offset:20480
    v_mfma_f32_16x16x32_bf16 v[140:143], v[72:75], a[28:31], v[140:143]
    ds_read_b64_tr_b16 v[56:57], v4 offset:34816
    v_mfma_f32_16x16x32_bf16 v[144:147], v[76:79], a[16:19], v[144:147]
    ds_read_b64_tr_b16 v[58:59], v4 offset:35840
    v_mfma_f32_16x16x32_bf16 v[148:151], v[76:79], a[20:23], v[148:151]
    ds_read_b64_tr_b16 v[60:61], v5 offset:34816
    v_mfma_f32_16x16x32_bf16 v[152:155], v[76:79], a[24:27], v[152:155]
    ds_read_b64_tr_b16 v[62:63], v5 offset:35840
    v_mfma_f32_16x16x32_bf16 v[156:159], v[76:79], a[28:31], v[156:159]
    ds_read_b128 a[12:15], v6 offset:22528
    v_mfma_f32_16x16x32_bf16 v[160:163], v[80:83], a[16:19], v[160:163]
    v_mfma_f32_16x16x32_bf16 v[164:167], v[80:83], a[20:23], v[164:167]
    v_mfma_f32_16x16x32_bf16 v[168:171], v[80:83], a[24:27], v[168:171]
    v_mfma_f32_16x16x32_bf16 v[172:175], v[80:83], a[28:31], v[172:175]
    v_mfma_f32_16x16x32_bf16 v[176:179], v[84:87], a[16:19], v[176:179]
    v_mfma_f32_16x16x32_bf16 v[180:183], v[84:87], a[20:23], v[180:183]
    v_mfma_f32_16x16x32_bf16 v[184:187], v[84:87], a[24:27], v[184:187]
    v_mfma_f32_16x16x32_bf16 v[188:191], v[84:87], a[28:31], v[188:191]
    v_mfma_f32_16x16x32_bf16 v[192:195], v[88:91], a[16:19], v[192:195]
    v_mfma_f32_16x16x32_bf16 v[196:199], v[88:91], a[20:23], v[196:199]
    v_mfma_f32_16x16x32_bf16 v[200:203], v[88:91], a[24:27], v[200:203]
    v_mfma_f32_16x16x32_bf16 v[204:207], v[88:91], a[28:31], v[204:207]
    s_waitcnt lgkmcnt(0)
    s_barrier
    v_mfma_f32_16x16x32_bf16 v[208:211], v[92:95], a[16:19], v[208:211]
    ds_read_b64_tr_b16 v[64:65], v2 offset:49152
    v_mfma_f32_16x16x32_bf16 v[212:215], v[92:95], a[20:23], v[212:215]
    ds_read_b64_tr_b16 v[66:67], v2 offset:50176
    v_mfma_f32_16x16x32_bf16 v[216:219], v[92:95], a[24:27], v[216:219]
    ds_read_b64_tr_b16 v[68:69], v3 offset:49152
    v_mfma_f32_16x16x32_bf16 v[220:223], v[92:95], a[28:31], v[220:223]
    ds_read_b64_tr_b16 v[70:71], v3 offset:50176
    v_mfma_f32_16x16x32_bf16 v[96:99], v[32:35], a[0:3], v[96:99]
    ds_read_b128 a[16:19], v7 offset:16384
    v_mfma_f32_16x16x32_bf16 v[100:103], v[32:35], a[4:7], v[100:103]
    ds_read_b64_tr_b16 v[72:73], v4 offset:49152
    v_mfma_f32_16x16x32_bf16 v[104:107], v[32:35], a[8:11], v[104:107]
    ds_read_b64_tr_b16 v[74:75], v4 offset:50176
    v_mfma_f32_16x16x32_bf16 v[108:111], v[32:35], a[12:15], v[108:111]
    ds_read_b64_tr_b16 v[76:77], v5 offset:49152
    v_mfma_f32_16x16x32_bf16 v[112:115], v[36:39], a[0:3], v[112:115]
    ds_read_b64_tr_b16 v[78:79], v5 offset:50176
    v_mfma_f32_16x16x32_bf16 v[116:119], v[36:39], a[4:7], v[116:119]
    ds_read_b128 a[20:23], v7 offset:18432
    v_mfma_f32_16x16x32_bf16 v[120:123], v[36:39], a[8:11], v[120:123]
    ds_read_b64_tr_b16 v[80:81], v2 offset:51200
    v_mfma_f32_16x16x32_bf16 v[124:127], v[36:39], a[12:15], v[124:127]
    ds_read_b64_tr_b16 v[82:83], v2 offset:52224
    v_mfma_f32_16x16x32_bf16 v[128:131], v[40:43], a[0:3], v[128:131]
    ds_read_b64_tr_b16 v[84:85], v3 offset:51200
    v_mfma_f32_16x16x32_bf16 v[132:135], v[40:43], a[4:7], v[132:135]
    ds_read_b64_tr_b16 v[86:87], v3 offset:52224
    v_mfma_f32_16x16x32_bf16 v[136:139], v[40:43], a[8:11], v[136:139]
    ds_read_b128 a[24:27], v7 offset:20480
    v_mfma_f32_16x16x32_bf16 v[140:143], v[40:43], a[12:15], v[140:143]
    ds_read_b64_tr_b16 v[88:89], v4 offset:51200
    v_mfma_f32_16x16x32_bf16 v[144:147], v[44:47], a[0:3], v[144:147]
    ds_read_b64_tr_b16 v[90:91], v4 offset:52224
    v_mfma_f32_16x16x32_bf16 v[148:151], v[44:47], a[4:7], v[148:151]
    ds_read_b64_tr_b16 v[92:93], v5 offset:51200
    v_mfma_f32_16x16x32_bf16 v[152:155], v[44:47], a[8:11], v[152:155]
    ds_read_b64_tr_b16 v[94:95], v5 offset:52224
    v_mfma_f32_16x16x32_bf16 v[156:159], v[44:47], a[12:15], v[156:159]
    ds_read_b128 a[28:31], v7 offset:22528
    v_mfma_f32_16x16x32_bf16 v[160:163], v[48:51], a[0:3], v[160:163]
    v_mfma_f32_16x16x32_bf16 v[164:167], v[48:51], a[4:7], v[164:167]
    v_mfma_f32_16x16x32_bf16 v[168:171], v[48:51], a[8:11], v[168:171]
    v_mfma_f32_16x16x32_bf16 v[172:175], v[48:51], a[12:15], v[172:175]
    v_mfma_f32_16x16x32_bf16 v[176:179], v[52:55], a[0:3], v[176:179]
    v_mfma_f32_16x16x32_bf16 v[180:183], v[52:55], a[4:7], v[180:183]
    v_mfma_f32_16x16x32_bf16 v[184:187], v[52:55], a[8:11], v[184:187]
    v_mfma_f32_16x16x32_bf16 v[188:191], v[52:55], a[12:15], v[188:191]
    v_mfma_f32_16x16x32_bf16 v[192:195], v[56:59], a[0:3], v[192:195]
    v_mfma_f32_16x16x32_bf16 v[196:199], v[56:59], a[4:7], v[196:199]
    v_mfma_f32_16x16x32_bf16 v[200:203], v[56:59], a[8:11], v[200:203]
    v_mfma_f32_16x16x32_bf16 v[204:207], v[56:59], a[12:15], v[204:207]
    s_waitcnt lgkmcnt(0)
    s_barrier
    v_mfma_f32_16x16x32_bf16 v[208:211], v[60:63], a[0:3], v[208:211]
    ds_read_b64_tr_b16 v[32:33], v2 offset:0
    v_mfma_f32_16x16x32_bf16 v[212:215], v[60:63], a[4:7], v[212:215]
    ds_read_b64_tr_b16 v[34:35], v2 offset:1024
    v_mfma_f32_16x16x32_bf16 v[216:219], v[60:63], a[8:11], v[216:219]
    ds_read_b64_tr_b16 v[36:37], v3 offset:0
    v_mfma_f32_16x16x32_bf16 v[220:223], v[60:63], a[12:15], v[220:223]
    ds_read_b64_tr_b16 v[38:39], v3 offset:1024
    v_mfma_f32_16x16x32_bf16 v[96:99], v[64:67], a[16:19], v[96:99]
    ds_read_b128 a[0:3], v6 offset:32768
    v_mfma_f32_16x16x32_bf16 v[100:103], v[64:67], a[20:23], v[100:103]
    ds_read_b64_tr_b16 v[40:41], v4 offset:0
    v_mfma_f32_16x16x32_bf16 v[104:107], v[64:67], a[24:27], v[104:107]
    ds_read_b64_tr_b16 v[42:43], v4 offset:1024
    v_mfma_f32_16x16x32_bf16 v[108:111], v[64:67], a[28:31], v[108:111]
    ds_read_b64_tr_b16 v[44:45], v5 offset:0
    v_mfma_f32_16x16x32_bf16 v[112:115], v[68:71], a[16:19], v[112:115]
    ds_read_b64_tr_b16 v[46:47], v5 offset:1024
    v_mfma_f32_16x16x32_bf16 v[116:119], v[68:71], a[20:23], v[116:119]
    ds_read_b128 a[4:7], v6 offset:34816
    v_mfma_f32_16x16x32_bf16 v[120:123], v[68:71], a[24:27], v[120:123]
    ds_read_b64_tr_b16 v[48:49], v2 offset:2048
    v_mfma_f32_16x16x32_bf16 v[124:127], v[68:71], a[28:31], v[124:127]
    ds_read_b64_tr_b16 v[50:51], v2 offset:3072
    v_mfma_f32_16x16x32_bf16 v[128:131], v[72:75], a[16:19], v[128:131]
    ds_read_b64_tr_b16 v[52:53], v3 offset:2048
    v_mfma_f32_16x16x32_bf16 v[132:135], v[72:75], a[20:23], v[132:135]
    ds_read_b64_tr_b16 v[54:55], v3 offset:3072
    v_mfma_f32_16x16x32_bf16 v[136:139], v[72:75], a[24:27], v[136:139]
    ds_read_b128 a[8:11], v6 offset:36864
    v_mfma_f32_16x16x32_bf16 v[140:143], v[72:75], a[28:31], v[140:143]
    ds_read_b64_tr_b16 v[56:57], v4 offset:2048
    v_mfma_f32_16x16x32_bf16 v[144:147], v[76:79], a[16:19], v[144:147]
    ds_read_b64_tr_b16 v[58:59], v4 offset:3072
    v_mfma_f32_16x16x32_bf16 v[148:151], v[76:79], a[20:23], v[148:151]
    ds_read_b64_tr_b16 v[60:61], v5 offset:2048
    v_mfma_f32_16x16x32_bf16 v[152:155], v[76:79], a[24:27], v[152:155]
    ds_read_b64_tr_b16 v[62:63], v5 offset:3072
    v_mfma_f32_16x16x32_bf16 v[156:159], v[76:79], a[28:31], v[156:159]
    ds_read_b128 a[12:15], v6 offset:38912
    v_mfma_f32_16x16x32_bf16 v[160:163], v[80:83], a[16:19], v[160:163]
    v_mfma_f32_16x16x32_bf16 v[164:167], v[80:83], a[20:23], v[164:167]
    v_mfma_f32_16x16x32_bf16 v[168:171], v[80:83], a[24:27], v[168:171]
    v_mfma_f32_16x16x32_bf16 v[172:175], v[80:83], a[28:31], v[172:175]
    v_mfma_f32_16x16x32_bf16 v[176:179], v[84:87], a[16:19], v[176:179]
    v_mfma_f32_16x16x32_bf16 v[180:183], v[84:87], a[20:23], v[180:183]
    v_mfma_f32_16x16x32_bf16 v[184:187], v[84:87], a[24:27], v[184:187]
    v_mfma_f32_16x16x32_bf16 v[188:191], v[84:87], a[28:31], v[188:191]
    v_mfma_f32_16x16x32_bf16 v[192:195], v[88:91], a[16:19], v[192:195]
    v_mfma_f32_16x16x32_bf16 v[196:199], v[88:91], a[20:23], v[196:199]
    v_mfma_f32_16x16x32_bf16 v[200:203], v[88:91], a[24:27], v[200:203]
    v_mfma_f32_16x16x32_bf16 v[204:207], v[88:91], a[28:31], v[204:207]
    s_waitcnt lgkmcnt(0)
    s_barrier
    v_mfma_f32_16x16x32_bf16 v[208:211], v[92:95], a[16:19], v[208:211]
    ds_read_b64_tr_b16 v[64:65], v2 offset:16384
    v_mfma_f32_16x16x32_bf16 v[212:215], v[92:95], a[20:23], v[212:215]
    ds_read_b64_tr_b16 v[66:67], v2 offset:17408
    v_mfma_f32_16x16x32_bf16 v[216:219], v[92:95], a[24:27], v[216:219]
    ds_read_b64_tr_b16 v[68:69], v3 offset:16384
    v_mfma_f32_16x16x32_bf16 v[220:223], v[92:95], a[28:31], v[220:223]
    ds_read_b64_tr_b16 v[70:71], v3 offset:17408
    v_mfma_f32_16x16x32_bf16 v[96:99], v[32:35], a[0:3], v[96:99]
    ds_read_b128 a[16:19], v7 offset:32768
    v_mfma_f32_16x16x32_bf16 v[100:103], v[32:35], a[4:7], v[100:103]
    ds_read_b64_tr_b16 v[72:73], v4 offset:16384
    v_mfma_f32_16x16x32_bf16 v[104:107], v[32:35], a[8:11], v[104:107]
    ds_read_b64_tr_b16 v[74:75], v4 offset:17408
    v_mfma_f32_16x16x32_bf16 v[108:111], v[32:35], a[12:15], v[108:111]
    ds_read_b64_tr_b16 v[76:77], v5 offset:16384
    v_mfma_f32_16x16x32_bf16 v[112:115], v[36:39], a[0:3], v[112:115]
    ds_read_b64_tr_b16 v[78:79], v5 offset:17408
    v_mfma_f32_16x16x32_bf16 v[116:119], v[36:39], a[4:7], v[116:119]
    ds_read_b128 a[20:23], v7 offset:34816
    v_mfma_f32_16x16x32_bf16 v[120:123], v[36:39], a[8:11], v[120:123]
    ds_read_b64_tr_b16 v[80:81], v2 offset:18432
    v_mfma_f32_16x16x32_bf16 v[124:127], v[36:39], a[12:15], v[124:127]
    ds_read_b64_tr_b16 v[82:83], v2 offset:19456
    v_mfma_f32_16x16x32_bf16 v[128:131], v[40:43], a[0:3], v[128:131]
    ds_read_b64_tr_b16 v[84:85], v3 offset:18432
    v_mfma_f32_16x16x32_bf16 v[132:135], v[40:43], a[4:7], v[132:135]
    ds_read_b64_tr_b16 v[86:87], v3 offset:19456
    v_mfma_f32_16x16x32_bf16 v[136:139], v[40:43], a[8:11], v[136:139]
    ds_read_b128 a[24:27], v7 offset:36864
    v_mfma_f32_16x16x32_bf16 v[140:143], v[40:43], a[12:15], v[140:143]
    ds_read_b64_tr_b16 v[88:89], v4 offset:18432
    v_mfma_f32_16x16x32_bf16 v[144:147], v[44:47], a[0:3], v[144:147]
    ds_read_b64_tr_b16 v[90:91], v4 offset:19456
    v_mfma_f32_16x16x32_bf16 v[148:151], v[44:47], a[4:7], v[148:151]
    ds_read_b64_tr_b16 v[92:93], v5 offset:18432
    v_mfma_f32_16x16x32_bf16 v[152:155], v[44:47], a[8:11], v[152:155]
    ds_read_b64_tr_b16 v[94:95], v5 offset:19456
    v_mfma_f32_16x16x32_bf16 v[156:159], v[44:47], a[12:15], v[156:159]
    ds_read_b128 a[28:31], v7 offset:38912
    v_mfma_f32_16x16x32_bf16 v[160:163], v[48:51], a[0:3], v[160:163]
    v_mfma_f32_16x16x32_bf16 v[164:167], v[48:51], a[4:7], v[164:167]
    v_mfma_f32_16x16x32_bf16 v[168:171], v[48:51], a[8:11], v[168:171]
    v_mfma_f32_16x16x32_bf16 v[172:175], v[48:51], a[12:15], v[172:175]
    v_mfma_f32_16x16x32_bf16 v[176:179], v[52:55], a[0:3], v[176:179]
    v_mfma_f32_16x16x32_bf16 v[180:183], v[52:55], a[4:7], v[180:183]
    v_mfma_f32_16x16x32_bf16 v[184:187], v[52:55], a[8:11], v[184:187]
    v_mfma_f32_16x16x32_bf16 v[188:191], v[52:55], a[12:15], v[188:191]
    v_mfma_f32_16x16x32_bf16 v[192:195], v[56:59], a[0:3], v[192:195]
    v_mfma_f32_16x16x32_bf16 v[196:199], v[56:59], a[4:7], v[196:199]
    v_mfma_f32_16x16x32_bf16 v[200:203], v[56:59], a[8:11], v[200:203]
    v_mfma_f32_16x16x32_bf16 v[204:207], v[56:59], a[12:15], v[204:207]
    s_waitcnt lgkmcnt(0)
    s_barrier
    v_mfma_f32_16x16x32_bf16 v[208:211], v[60:63], a[0:3], v[208:211]
    ds_read_b64_tr_b16 v[32:33], v2 offset:32768
    v_mfma_f32_16x16x32_bf16 v[212:215], v[60:63], a[4:7], v[212:215]
    ds_read_b64_tr_b16 v[34:35], v2 offset:33792
    v_mfma_f32_16x16x32_bf16 v[216:219], v[60:63], a[8:11], v[216:219]
    ds_read_b64_tr_b16 v[36:37], v3 offset:32768
    v_mfma_f32_16x16x32_bf16 v[220:223], v[60:63], a[12:15], v[220:223]
    ds_read_b64_tr_b16 v[38:39], v3 offset:33792
    v_mfma_f32_16x16x32_bf16 v[96:99], v[64:67], a[16:19], v[96:99]
    ds_read_b128 a[0:3], v6 offset:0
    v_mfma_f32_16x16x32_bf16 v[100:103], v[64:67], a[20:23], v[100:103]
    ds_read_b64_tr_b16 v[40:41], v4 offset:32768
    v_mfma_f32_16x16x32_bf16 v[104:107], v[64:67], a[24:27], v[104:107]
    ds_read_b64_tr_b16 v[42:43], v4 offset:33792
    v_mfma_f32_16x16x32_bf16 v[108:111], v[64:67], a[28:31], v[108:111]
    ds_read_b64_tr_b16 v[44:45], v5 offset:32768
    v_mfma_f32_16x16x32_bf16 v[112:115], v[68:71], a[16:19], v[112:115]
    ds_read_b64_tr_b16 v[46:47], v5 offset:33792
    v_mfma_f32_16x16x32_bf16 v[116:119], v[68:71], a[20:23], v[116:119]
    ds_read_b128 a[4:7], v6 offset:2048
    v_mfma_f32_16x16x32_bf16 v[120:123], v[68:71], a[24:27], v[120:123]
    ds_read_b64_tr_b16 v[48:49], v2 offset:34816
    v_mfma_f32_16x16x32_bf16 v[124:127], v[68:71], a[28:31], v[124:127]
    ds_read_b64_tr_b16 v[50:51], v2 offset:35840
    v_mfma_f32_16x16x32_bf16 v[128:131], v[72:75], a[16:19], v[128:131]
    ds_read_b64_tr_b16 v[52:53], v3 offset:34816
    v_mfma_f32_16x16x32_bf16 v[132:135], v[72:75], a[20:23], v[132:135]
    ds_read_b64_tr_b16 v[54:55], v3 offset:35840
    v_mfma_f32_16x16x32_bf16 v[136:139], v[72:75], a[24:27], v[136:139]
    ds_read_b128 a[8:11], v6 offset:4096
    v_mfma_f32_16x16x32_bf16 v[140:143], v[72:75], a[28:31], v[140:143]
    ds_read_b64_tr_b16 v[56:57], v4 offset:34816
    v_mfma_f32_16x16x32_bf16 v[144:147], v[76:79], a[16:19], v[144:147]
    ds_read_b64_tr_b16 v[58:59], v4 offset:35840
    v_mfma_f32_16x16x32_bf16 v[148:151], v[76:79], a[20:23], v[148:151]
    ds_read_b64_tr_b16 v[60:61], v5 offset:34816
    v_mfma_f32_16x16x32_bf16 v[152:155], v[76:79], a[24:27], v[152:155]
    ds_read_b64_tr_b16 v[62:63], v5 offset:35840
    v_mfma_f32_16x16x32_bf16 v[156:159], v[76:79], a[28:31], v[156:159]
    ds_read_b128 a[12:15], v6 offset:6144
    v_mfma_f32_16x16x32_bf16 v[160:163], v[80:83], a[16:19], v[160:163]
    v_mfma_f32_16x16x32_bf16 v[164:167], v[80:83], a[20:23], v[164:167]
    v_mfma_f32_16x16x32_bf16 v[168:171], v[80:83], a[24:27], v[168:171]
    v_mfma_f32_16x16x32_bf16 v[172:175], v[80:83], a[28:31], v[172:175]
    v_mfma_f32_16x16x32_bf16 v[176:179], v[84:87], a[16:19], v[176:179]
    buffer_load_dword v27, off, s[60:63], 0 sc1
    v_mfma_f32_16x16x32_bf16 v[180:183], v[84:87], a[20:23], v[180:183]
    v_mfma_f32_16x16x32_bf16 v[184:187], v[84:87], a[24:27], v[184:187]
    v_mfma_f32_16x16x32_bf16 v[188:191], v[84:87], a[28:31], v[188:191]
    v_mfma_f32_16x16x32_bf16 v[192:195], v[88:91], a[16:19], v[192:195]
    v_mfma_f32_16x16x32_bf16 v[196:199], v[88:91], a[20:23], v[196:199]
    v_mfma_f32_16x16x32_bf16 v[200:203], v[88:91], a[24:27], v[200:203]
    v_mfma_f32_16x16x32_bf16 v[204:207], v[88:91], a[28:31], v[204:207]
    s_waitcnt lgkmcnt(0)
    s_barrier
    v_mfma_f32_16x16x32_bf16 v[208:211], v[92:95], a[16:19], v[208:211]
    ds_read_b64_tr_b16 v[64:65], v2 offset:49152
    v_mfma_f32_16x16x32_bf16 v[212:215], v[92:95], a[20:23], v[212:215]
    ds_read_b64_tr_b16 v[66:67], v2 offset:50176
    v_mfma_f32_16x16x32_bf16 v[216:219], v[92:95], a[24:27], v[216:219]
    ds_read_b64_tr_b16 v[68:69], v3 offset:49152
    v_mfma_f32_16x16x32_bf16 v[220:223], v[92:95], a[28:31], v[220:223]
    ds_read_b64_tr_b16 v[70:71], v3 offset:50176
    v_mfma_f32_16x16x32_bf16 v[96:99], v[32:35], a[0:3], v[96:99]
    ds_read_b128 a[16:19], v7 offset:0
    v_mfma_f32_16x16x32_bf16 v[100:103], v[32:35], a[4:7], v[100:103]
    ds_read_b64_tr_b16 v[72:73], v4 offset:49152
    v_mfma_f32_16x16x32_bf16 v[104:107], v[32:35], a[8:11], v[104:107]
    ds_read_b64_tr_b16 v[74:75], v4 offset:50176
    v_mfma_f32_16x16x32_bf16 v[108:111], v[32:35], a[12:15], v[108:111]
    ds_read_b64_tr_b16 v[76:77], v5 offset:49152
    v_mfma_f32_16x16x32_bf16 v[112:115], v[36:39], a[0:3], v[112:115]
    ds_read_b64_tr_b16 v[78:79], v5 offset:50176
    v_mfma_f32_16x16x32_bf16 v[116:119], v[36:39], a[4:7], v[116:119]
    ds_read_b128 a[20:23], v7 offset:2048
    v_mfma_f32_16x16x32_bf16 v[120:123], v[36:39], a[8:11], v[120:123]
    ds_read_b64_tr_b16 v[80:81], v2 offset:51200
    v_mfma_f32_16x16x32_bf16 v[124:127], v[36:39], a[12:15], v[124:127]
    ds_read_b64_tr_b16 v[82:83], v2 offset:52224
    v_mfma_f32_16x16x32_bf16 v[128:131], v[40:43], a[0:3], v[128:131]
    ds_read_b64_tr_b16 v[84:85], v3 offset:51200
    v_mfma_f32_16x16x32_bf16 v[132:135], v[40:43], a[4:7], v[132:135]
    ds_read_b64_tr_b16 v[86:87], v3 offset:52224
    v_mfma_f32_16x16x32_bf16 v[136:139], v[40:43], a[8:11], v[136:139]
    ds_read_b128 a[24:27], v7 offset:4096
    v_mfma_f32_16x16x32_bf16 v[140:143], v[40:43], a[12:15], v[140:143]
    ds_read_b64_tr_b16 v[88:89], v4 offset:51200
    v_mfma_f32_16x16x32_bf16 v[144:147], v[44:47], a[0:3], v[144:147]
    ds_read_b64_tr_b16 v[90:91], v4 offset:52224
    v_mfma_f32_16x16x32_bf16 v[148:151], v[44:47], a[4:7], v[148:151]
    ds_read_b64_tr_b16 v[92:93], v5 offset:51200
    v_mfma_f32_16x16x32_bf16 v[152:155], v[44:47], a[8:11], v[152:155]
    ds_read_b64_tr_b16 v[94:95], v5 offset:52224
    v_mfma_f32_16x16x32_bf16 v[156:159], v[44:47], a[12:15], v[156:159]
    ds_read_b128 a[28:31], v7 offset:6144
    v_mfma_f32_16x16x32_bf16 v[160:163], v[48:51], a[0:3], v[160:163]
    v_mfma_f32_16x16x32_bf16 v[164:167], v[48:51], a[4:7], v[164:167]
    v_mfma_f32_16x16x32_bf16 v[168:171], v[48:51], a[8:11], v[168:171]
    v_mfma_f32_16x16x32_bf16 v[172:175], v[48:51], a[12:15], v[172:175]
    v_mfma_f32_16x16x32_bf16 v[176:179], v[52:55], a[0:3], v[176:179]
    v_mfma_f32_16x16x32_bf16 v[180:183], v[52:55], a[4:7], v[180:183]
    v_mfma_f32_16x16x32_bf16 v[184:187], v[52:55], a[8:11], v[184:187]
    v_mfma_f32_16x16x32_bf16 v[188:191], v[52:55], a[12:15], v[188:191]
    v_mfma_f32_16x16x32_bf16 v[192:195], v[56:59], a[0:3], v[192:195]
    v_mfma_f32_16x16x32_bf16 v[196:199], v[56:59], a[4:7], v[196:199]
    v_mfma_f32_16x16x32_bf16 v[200:203], v[56:59], a[8:11], v[200:203]
    v_mfma_f32_16x16x32_bf16 v[204:207], v[56:59], a[12:15], v[204:207]
    s_waitcnt lgkmcnt(0)
    s_barrier
    v_mfma_f32_16x16x32_bf16 v[208:211], v[60:63], a[0:3], v[208:211]
    ds_read_b64_tr_b16 v[32:33], v2 offset:0
    v_mfma_f32_16x16x32_bf16 v[212:215], v[60:63], a[4:7], v[212:215]
    ds_read_b64_tr_b16 v[34:35], v2 offset:1024
    v_mfma_f32_16x16x32_bf16 v[216:219], v[60:63], a[8:11], v[216:219]
    ds_read_b64_tr_b16 v[36:37], v3 offset:0
    v_mfma_f32_16x16x32_bf16 v[220:223], v[60:63], a[12:15], v[220:223]
    ds_read_b64_tr_b16 v[38:39], v3 offset:1024
    v_mfma_f32_16x16x32_bf16 v[96:99], v[64:67], a[16:19], v[96:99]
    ds_read_b128 a[0:3], v6 offset:16384
    v_mfma_f32_16x16x32_bf16 v[100:103], v[64:67], a[20:23], v[100:103]
    ds_read_b64_tr_b16 v[40:41], v4 offset:0
    v_mfma_f32_16x16x32_bf16 v[104:107], v[64:67], a[24:27], v[104:107]
    ds_read_b64_tr_b16 v[42:43], v4 offset:1024
    v_mfma_f32_16x16x32_bf16 v[108:111], v[64:67], a[28:31], v[108:111]
    ds_read_b64_tr_b16 v[44:45], v5 offset:0
    v_mfma_f32_16x16x32_bf16 v[112:115], v[68:71], a[16:19], v[112:115]
    ds_read_b64_tr_b16 v[46:47], v5 offset:1024
    v_mfma_f32_16x16x32_bf16 v[116:119], v[68:71], a[20:23], v[116:119]
    ds_read_b128 a[4:7], v6 offset:18432
    v_mfma_f32_16x16x32_bf16 v[120:123], v[68:71], a[24:27], v[120:123]
    ds_read_b64_tr_b16 v[48:49], v2 offset:2048
    v_mfma_f32_16x16x32_bf16 v[124:127], v[68:71], a[28:31], v[124:127]
    ds_read_b64_tr_b16 v[50:51], v2 offset:3072
    v_mfma_f32_16x16x32_bf16 v[128:131], v[72:75], a[16:19], v[128:131]
    ds_read_b64_tr_b16 v[52:53], v3 offset:2048
    v_mfma_f32_16x16x32_bf16 v[132:135], v[72:75], a[20:23], v[132:135]
    ds_read_b64_tr_b16 v[54:55], v3 offset:3072
    v_mfma_f32_16x16x32_bf16 v[136:139], v[72:75], a[24:27], v[136:139]
    ds_read_b128 a[8:11], v6 offset:20480
    v_mfma_f32_16x16x32_bf16 v[140:143], v[72:75], a[28:31], v[140:143]
    ds_read_b64_tr_b16 v[56:57], v4 offset:2048
    v_mfma_f32_16x16x32_bf16 v[144:147], v[76:79], a[16:19], v[144:147]
    ds_read_b64_tr_b16 v[58:59], v4 offset:3072
    v_mfma_f32_16x16x32_bf16 v[148:151], v[76:79], a[20:23], v[148:151]
    ds_read_b64_tr_b16 v[60:61], v5 offset:2048
    v_mfma_f32_16x16x32_bf16 v[152:155], v[76:79], a[24:27], v[152:155]
    ds_read_b64_tr_b16 v[62:63], v5 offset:3072
    v_mfma_f32_16x16x32_bf16 v[156:159], v[76:79], a[28:31], v[156:159]
    ds_read_b128 a[12:15], v6 offset:22528
    v_mfma_f32_16x16x32_bf16 v[160:163], v[80:83], a[16:19], v[160:163]
    v_mfma_f32_16x16x32_bf16 v[164:167], v[80:83], a[20:23], v[164:167]
    v_mfma_f32_16x16x32_bf16 v[168:171], v[80:83], a[24:27], v[168:171]
    v_mfma_f32_16x16x32_bf16 v[172:175], v[80:83], a[28:31], v[172:175]
    v_mfma_f32_16x16x32_bf16 v[176:179], v[84:87], a[16:19], v[176:179]
    v_mfma_f32_16x16x32_bf16 v[180:183], v[84:87], a[20:23], v[180:183]
    v_mfma_f32_16x16x32_bf16 v[184:187], v[84:87], a[24:27], v[184:187]
    v_mfma_f32_16x16x32_bf16 v[188:191], v[84:87], a[28:31], v[188:191]
    v_mfma_f32_16x16x32_bf16 v[192:195], v[88:91], a[16:19], v[192:195]
    v_mfma_f32_16x16x32_bf16 v[196:199], v[88:91], a[20:23], v[196:199]
    v_mfma_f32_16x16x32_bf16 v[200:203], v[88:91], a[24:27], v[200:203]
    v_mfma_f32_16x16x32_bf16 v[204:207], v[88:91], a[28:31], v[204:207]
    s_waitcnt lgkmcnt(0)
    s_barrier
    v_mfma_f32_16x16x32_bf16 v[208:211], v[92:95], a[16:19], v[208:211]
    ds_read_b64_tr_b16 v[64:65], v2 offset:16384
    v_mfma_f32_16x16x32_bf16 v[212:215], v[92:95], a[20:23], v[212:215]
    ds_read_b64_tr_b16 v[66:67], v2 offset:17408
    v_mfma_f32_16x16x32_bf16 v[216:219], v[92:95], a[24:27], v[216:219]
    ds_read_b64_tr_b16 v[68:69], v3 offset:16384
    v_mfma_f32_16x16x32_bf16 v[220:223], v[92:95], a[28:31], v[220:223]
    ds_read_b64_tr_b16 v[70:71], v3 offset:17408
    v_mfma_f32_16x16x32_bf16 v[96:99], v[32:35], a[0:3], v[96:99]
    ds_read_b128 a[16:19], v7 offset:16384
    v_mfma_f32_16x16x32_bf16 v[100:103], v[32:35], a[4:7], v[100:103]
    ds_read_b64_tr_b16 v[72:73], v4 offset:16384
    v_mfma_f32_16x16x32_bf16 v[104:107], v[32:35], a[8:11], v[104:107]
    ds_read_b64_tr_b16 v[74:75], v4 offset:17408
    v_mfma_f32_16x16x32_bf16 v[108:111], v[32:35], a[12:15], v[108:111]
    ds_read_b64_tr_b16 v[76:77], v5 offset:16384
    v_mfma_f32_16x16x32_bf16 v[112:115], v[36:39], a[0:3], v[112:115]
    ds_read_b64_tr_b16 v[78:79], v5 offset:17408
    v_mfma_f32_16x16x32_bf16 v[116:119], v[36:39], a[4:7], v[116:119]
    ds_read_b128 a[20:23], v7 offset:18432
    v_mfma_f32_16x16x32_bf16 v[120:123], v[36:39], a[8:11], v[120:123]
    ds_read_b64_tr_b16 v[80:81], v2 offset:18432
    v_mfma_f32_16x16x32_bf16 v[124:127], v[36:39], a[12:15], v[124:127]
    ds_read_b64_tr_b16 v[82:83], v2 offset:19456
    v_mfma_f32_16x16x32_bf16 v[128:131], v[40:43], a[0:3], v[128:131]
    ds_read_b64_tr_b16 v[84:85], v3 offset:18432
    v_mfma_f32_16x16x32_bf16 v[132:135], v[40:43], a[4:7], v[132:135]
    ds_read_b64_tr_b16 v[86:87], v3 offset:19456
    v_mfma_f32_16x16x32_bf16 v[136:139], v[40:43], a[8:11], v[136:139]
    ds_read_b128 a[24:27], v7 offset:20480
    v_mfma_f32_16x16x32_bf16 v[140:143], v[40:43], a[12:15], v[140:143]
    ds_read_b64_tr_b16 v[88:89], v4 offset:18432
    v_mfma_f32_16x16x32_bf16 v[144:147], v[44:47], a[0:3], v[144:147]
    ds_read_b64_tr_b16 v[90:91], v4 offset:19456
    v_mfma_f32_16x16x32_bf16 v[148:151], v[44:47], a[4:7], v[148:151]
    ds_read_b64_tr_b16 v[92:93], v5 offset:18432
    v_mfma_f32_16x16x32_bf16 v[152:155], v[44:47], a[8:11], v[152:155]
    ds_read_b64_tr_b16 v[94:95], v5 offset:19456
    v_mfma_f32_16x16x32_bf16 v[156:159], v[44:47], a[12:15], v[156:159]
    ds_read_b128 a[28:31], v7 offset:22528
    v_mfma_f32_16x16x32_bf16 v[160:163], v[48:51], a[0:3], v[160:163]
    v_mfma_f32_16x16x32_bf16 v[164:167], v[48:51], a[4:7], v[164:167]
    v_mfma_f32_16x16x32_bf16 v[168:171], v[48:51], a[8:11], v[168:171]
    v_mfma_f32_16x16x32_bf16 v[172:175], v[48:51], a[12:15], v[172:175]
    v_mfma_f32_16x16x32_bf16 v[176:179], v[52:55], a[0:3], v[176:179]
    v_mfma_f32_16x16x32_bf16 v[180:183], v[52:55], a[4:7], v[180:183]
    v_mfma_f32_16x16x32_bf16 v[184:187], v[52:55], a[8:11], v[184:187]
    v_mfma_f32_16x16x32_bf16 v[188:191], v[52:55], a[12:15], v[188:191]
    v_mfma_f32_16x16x32_bf16 v[192:195], v[56:59], a[0:3], v[192:195]
    v_mfma_f32_16x16x32_bf16 v[196:199], v[56:59], a[4:7], v[196:199]
    v_mfma_f32_16x16x32_bf16 v[200:203], v[56:59], a[8:11], v[200:203]
    v_mfma_f32_16x16x32_bf16 v[204:207], v[56:59], a[12:15], v[204:207]
    s_waitcnt lgkmcnt(0)
    s_barrier
    v_mfma_f32_16x16x32_bf16 v[208:211], v[60:63], a[0:3], v[208:211]
    ds_read_b64_tr_b16 v[32:33], v2 offset:32768
    v_mfma_f32_16x16x32_bf16 v[212:215], v[60:63], a[4:7], v[212:215]
    ds_read_b64_tr_b16 v[34:35], v2 offset:33792
    v_mfma_f32_16x16x32_bf16 v[216:219], v[60:63], a[8:11], v[216:219]
    ds_read_b64_tr_b16 v[36:37], v3 offset:32768
    v_mfma_f32_16x16x32_bf16 v[220:223], v[60:63], a[12:15], v[220:223]
    ds_read_b64_tr_b16 v[38:39], v3 offset:33792
    v_mfma_f32_16x16x32_bf16 v[96:99], v[64:67], a[16:19], v[96:99]
    ds_read_b128 a[0:3], v6 offset:32768
    v_mfma_f32_16x16x32_bf16 v[100:103], v[64:67], a[20:23], v[100:103]
    ds_read_b64_tr_b16 v[40:41], v4 offset:32768
    v_mfma_f32_16x16x32_bf16 v[104:107], v[64:67], a[24:27], v[104:107]
    ds_read_b64_tr_b16 v[42:43], v4 offset:33792
    v_mfma_f32_16x16x32_bf16 v[108:111], v[64:67], a[28:31], v[108:111]
    ds_read_b64_tr_b16 v[44:45], v5 offset:32768
    v_mfma_f32_16x16x32_bf16 v[112:115], v[68:71], a[16:19], v[112:115]
    ds_read_b64_tr_b16 v[46:47], v5 offset:33792
    v_mfma_f32_16x16x32_bf16 v[116:119], v[68:71], a[20:23], v[116:119]
    ds_read_b128 a[4:7], v6 offset:34816
    v_mfma_f32_16x16x32_bf16 v[120:123], v[68:71], a[24:27], v[120:123]
    ds_read_b64_tr_b16 v[48:49], v2 offset:34816
    v_mfma_f32_16x16x32_bf16 v[124:127], v[68:71], a[28:31], v[124:127]
    ds_read_b64_tr_b16 v[50:51], v2 offset:35840
    v_mfma_f32_16x16x32_bf16 v[128:131], v[72:75], a[16:19], v[128:131]
    ds_read_b64_tr_b16 v[52:53], v3 offset:34816
    v_mfma_f32_16x16x32_bf16 v[132:135], v[72:75], a[20:23], v[132:135]
    ds_read_b64_tr_b16 v[54:55], v3 offset:35840
    v_mfma_f32_16x16x32_bf16 v[136:139], v[72:75], a[24:27], v[136:139]
    ds_read_b128 a[8:11], v6 offset:36864
    v_mfma_f32_16x16x32_bf16 v[140:143], v[72:75], a[28:31], v[140:143]
    ds_read_b64_tr_b16 v[56:57], v4 offset:34816
    v_mfma_f32_16x16x32_bf16 v[144:147], v[76:79], a[16:19], v[144:147]
    ds_read_b64_tr_b16 v[58:59], v4 offset:35840
    v_mfma_f32_16x16x32_bf16 v[148:151], v[76:79], a[20:23], v[148:151]
    ds_read_b64_tr_b16 v[60:61], v5 offset:34816
    v_mfma_f32_16x16x32_bf16 v[152:155], v[76:79], a[24:27], v[152:155]
    ds_read_b64_tr_b16 v[62:63], v5 offset:35840
    v_mfma_f32_16x16x32_bf16 v[156:159], v[76:79], a[28:31], v[156:159]
    ds_read_b128 a[12:15], v6 offset:38912
    v_mfma_f32_16x16x32_bf16 v[160:163], v[80:83], a[16:19], v[160:163]
    v_mfma_f32_16x16x32_bf16 v[164:167], v[80:83], a[20:23], v[164:167]
    v_mfma_f32_16x16x32_bf16 v[168:171], v[80:83], a[24:27], v[168:171]
    v_mfma_f32_16x16x32_bf16 v[172:175], v[80:83], a[28:31], v[172:175]
    v_mfma_f32_16x16x32_bf16 v[176:179], v[84:87], a[16:19], v[176:179]
    s_waitcnt vmcnt(0)
BACKN_29:
    v_readfirstlane_b32 s89, v27
    s_nop 0
    s_cmp_eq_u32 s89, 0
    s_cbranch_scc1 SLOWN_28
OKN_30:
    v_mfma_f32_16x16x32_bf16 v[180:183], v[84:87], a[20:23], v[180:183]
    v_mfma_f32_16x16x32_bf16 v[184:187], v[84:87], a[24:27], v[184:187]
    v_mfma_f32_16x16x32_bf16 v[188:191], v[84:87], a[28:31], v[188:191]
    v_mfma_f32_16x16x32_bf16 v[192:195], v[88:91], a[16:19], v[192:195]
    v_mfma_f32_16x16x32_bf16 v[196:199], v[88:91], a[20:23], v[196:199]
    v_mfma_f32_16x16x32_bf16 v[200:203], v[88:91], a[24:27], v[200:203]
    v_mfma_f32_16x16x32_bf16 v[204:207], v[88:91], a[28:31], v[204:207]
    s_waitcnt lgkmcnt(0)
    s_barrier
    v_mfma_f32_16x16x32_bf16 v[208:211], v[92:95], a[16:19], v[208:211]
    ds_read_b64_tr_b16 v[64:65], v2 offset:49152
    v_mfma_f32_16x16x32_bf16 v[212:215], v[92:95], a[20:23], v[212:215]
    ds_read_b64_tr_b16 v[66:67], v2 offset:50176
    v_mfma_f32_16x16x32_bf16 v[216:219], v[92:95], a[24:27], v[216:219]
    ds_read_b64_tr_b16 v[68:69], v3 offset:49152
    v_mfma_f32_16x16x32_bf16 v[220:223], v[92:95], a[28:31], v[220:223]
    ds_read_b64_tr_b16 v[70:71], v3 offset:50176
    v_mfma_f32_16x16x32_bf16 v[96:99], v[32:35], a[0:3], v[96:99]
    ds_read_b128 a[16:19], v7 offset:32768
    v_mfma_f32_16x16x32_bf16 v[100:103], v[32:35], a[4:7], v[100:103]
    ds_read_b64_tr_b16 v[72:73], v4 offset:49152
    v_mfma_f32_16x16x32_bf16 v[104:107], v[32:35], a[8:11], v[104:107]
    ds_read_b64_tr_b16 v[74:75], v4 offset:50176
    v_mfma_f32_16x16x32_bf16 v[108:111], v[32:35], a[12:15], v[108:111]
    ds_read_b64_tr_b16 v[76:77], v5 offset:49152
    v_mfma_f32_16x16x32_bf16 v[112:115], v[36:39], a[0:3], v[112:115]
    ds_read_b64_tr_b16 v[78:79], v5 offset:50176
    v_mfma_f32_16x16x32_bf16 v[116:119], v[36:39], a[4:7], v[116:119]
    ds_read_b128 a[20:23], v7 offset:34816
    v_mfma_f32_16x16x32_bf16 v[120:123], v[36:39], a[8:11], v[120:123]
    ds_read_b64_tr_b16 v[80:81], v2 offset:51200
    v_mfma_f32_16x16x32_bf16 v[124:127], v[36:39], a[12:15], v[124:127]
    ds_read_b64_tr_b16 v[82:83], v2 offset:52224
    v_mfma_f32_16x16x32_bf16 v[128:131], v[40:43], a[0:3], v[128:131]
    ds_read_b64_tr_b16 v[84:85], v3 offset:51200
    v_mfma_f32_16x16x32_bf16 v[132:135], v[40:43], a[4:7], v[132:135]
    ds_read_b64_tr_b16 v[86:87], v3 offset:52224
    v_mfma_f32_16x16x32_bf16 v[136:139], v[40:43], a[8:11], v[136:139]
    ds_read_b128 a[24:27], v7 offset:36864
    v_mfma_f32_16x16x32_bf16 v[140:143], v[40:43], a[12:15], v[140:143]
    ds_read_b64_tr_b16 v[88:89], v4 offset:51200
    v_mfma_f32_16x16x32_bf16 v[144:147], v[44:47], a[0:3], v[144:147]
    ds_read_b64_tr_b16 v[90:91], v4 offset:52224
    v_mfma_f32_16x16x32_bf16 v[148:151], v[44:47], a[4:7], v[148:151]
    ds_read_b64_tr_b16 v[92:93], v5 offset:51200
    v_mfma_f32_16x16x32_bf16 v[152:155], v[44:47], a[8:11], v[152:155]
    ds_read_b64_tr_b16 v[94:95], v5 offset:52224
    v_mfma_f32_16x16x32_bf16 v[156:159], v[44:47], a[12:15], v[156:159]
    ds_read_b128 a[28:31], v7 offset:38912
    v_mfma_f32_16x16x32_bf16 v[160:163], v[48:51], a[0:3], v[160:163]
    v_mfma_f32_16x16x32_bf16 v[164:167], v[48:51], a[4:7], v[164:167]
    v_mfma_f32_16x16x32_bf16 v[168:171], v[48:51], a[8:11], v[168:171]
    v_mfma_f32_16x16x32_bf16 v[172:175], v[48:51], a[12:15], v[172:175]
    v_mfma_f32_16x16x32_bf16 v[176:179], v[52:55], a[0:3], v[176:179]
    v_mfma_f32_16x16x32_bf16 v[180:183], v[52:55], a[4:7], v[180:183]
    v_mfma_f32_16x16x32_bf16 v[184:187], v[52:55], a[8:11], v[184:187]
    v_mfma_f32_16x16x32_bf16 v[188:191], v[52:55], a[12:15], v[188:191]
    v_mfma_f32_16x16x32_bf16 v[192:195], v[56:59], a[0:3], v[192:195]
    v_mfma_f32_16x16x32_bf16 v[196:199], v[56:59], a[4:7], v[196:199]
    v_mfma_f32_16x16x32_bf16 v[200:203], v[56:59], a[8:11], v[200:203]
    v_mfma_f32_16x16x32_bf16 v[204:207], v[56:59], a[12:15], v[204:207]
    s_waitcnt lgkmcnt(0)
    s_barrier
    v_mfma_f32_16x16x32_bf16 v[208:211], v[60:63], a[0:3], v[208:211]
    ds_read_b64_tr_b16 v[32:33], v2 offset:0
    v_mfma_f32_16x16x32_bf16 v[212:215], v[60:63], a[4:7], v[212:215]
    ds_read_b64_tr_b16 v[34:35], v2 offset:1024
    v_mfma_f32_16x16x32_bf16 v[216:219], v[60:63], a[8:11], v[216:219]
    ds_read_b64_tr_b16 v[36:37], v3 offset:0
    v_mfma_f32_16x16x32_bf16 v[220:223], v[60:63], a[12:15], v[220:223]
    ds_read_b64_tr_b16 v[38:39], v3 offset:1024
    v_mfma_f32_16x16x32_bf16 v[96:99], v[64:67], a[16:19], v[96:99]
    ds_read_b128 a[0:3], v6 offset:0
    v_mfma_f32_16x16x32_bf16 v[100:103], v[64:67], a[20:23], v[100:103]
    ds_read_b64_tr_b16 v[40:41], v4 offset:0
    v_mfma_f32_16x16x32_bf16 v[104:107], v[64:67], a[24:27], v[104:107]
    ds_read_b64_tr_b16 v[42:43], v4 offset:1024
    v_mfma_f32_16x16x32_bf16 v[108:111], v[64:67], a[28:31], v[108:111]
    ds_read_b64_tr_b16 v[44:45], v5 offset:0
    v_mfma_f32_16x16x32_bf16 v[112:115], v[68:71], a[16:19], v[112:115]
    ds_read_b64_tr_b16 v[46:47], v5 offset:1024
    v_mfma_f32_16x16x32_bf16 v[116:119], v[68:71], a[20:23], v[116:119]
    ds_read_b128 a[4:7], v6 offset:2048
    v_mfma_f32_16x16x32_bf16 v[120:123], v[68:71], a[24:27], v[120:123]
    ds_read_b64_tr_b16 v[48:49], v2 offset:2048
    v_mfma_f32_16x16x32_bf16 v[124:127], v[68:71], a[28:31], v[124:127]
    ds_read_b64_tr_b16 v[50:51], v2 offset:3072
    v_mfma_f32_16x16x32_bf16 v[128:131], v[72:75], a[16:19], v[128:131]
    ds_read_b64_tr_b16 v[52:53], v3 offset:2048
    v_mfma_f32_16x16x32_bf16 v[132:135], v[72:75], a[20:23], v[132:135]
    ds_read_b64_tr_b16 v[54:55], v3 offset:3072
    v_mfma_f32_16x16x32_bf16 v[136:139], v[72:75], a[24:27], v[136:139]
    ds_read_b128 a[8:11], v6 offset:4096
    v_mfma_f32_16x16x32_bf16 v[140:143], v[72:75], a[28:31], v[140:143]
    ds_read_b64_tr_b16 v[56:57], v4 offset:2048
    v_mfma_f32_16x16x32_bf16 v[144:147], v[76:79], a[16:19], v[144:147]
    ds_read_b64_tr_b16 v[58:59], v4 offset:3072
    v_mfma_f32_16x16x32_bf16 v[148:151], v[76:79], a[20:23], v[148:151]
    ds_read_b64_tr_b16 v[60:61], v5 offset:2048
    v_mfma_f32_16x16x32_bf16 v[152:155], v[76:79], a[24:27], v[152:155]
    ds_read_b64_tr_b16 v[62:63], v5 offset:3072
    v_mfma_f32_16x16x32_bf16 v[156:159], v[76:79], a[28:31], v[156:159]
    ds_read_b128 a[12:15], v6 offset:6144
    v_mfma_f32_16x16x32_bf16 v[160:163], v[80:83], a[16:19], v[160:163]
    v_mfma_f32_16x16x32_bf16 v[164:167], v[80:83], a[20:23], v[164:167]
    v_mfma_f32_16x16x32_bf16 v[168:171], v[80:83], a[24:27], v[168:171]
    v_mfma_f32_16x16x32_bf16 v[172:175], v[80:83], a[28:31], v[172:175]
    v_mfma_f32_16x16x32_bf16 v[176:179], v[84:87], a[16:19], v[176:179]
    v_mfma_f32_16x16x32_bf16 v[180:183], v[84:87], a[20:23], v[180:183]
    v_mfma_f32_16x16x32_bf16 v[184:187], v[84:87], a[24:27], v[184:187]
    v_mfma_f32_16x16x32_bf16 v[188:191], v[84:87], a[28:31], v[188:191]
    v_mfma_f32_16x16x32_bf16 v[192:195], v[88:91], a[16:19], v[192:195]
    v_mfma_f32_16x16x32_bf16 v[196:199], v[88:91], a[20:23], v[196:199]
    v_mfma_f32_16x16x32_bf16 v[200:203], v[88:91], a[24:27], v[200:203]
    v_mfma_f32_16x16x32_bf16 v[204:207], v[88:91], a[28:31], v[204:207]
    s_waitcnt lgkmcnt(0)
    s_barrier
    v_mfma_f32_16x16x32_bf16 v[208:211], v[92:95], a[16:19], v[208:211]
    ds_read_b64_tr_b16 v[64:65], v2 offset:16384
    v_mfma_f32_16x16x32_bf16 v[212:215], v[92:95], a[20:23], v[212:215]
    ds_read_b64_tr_b16 v[66:67], v2 offset:17408
    v_mfma_f32_16x16x32_bf16 v[216:219], v[92:95], a[24:27], v[216:219]
    ds_read_b64_tr_b16 v[68:69], v3 offset:16384
    v_mfma_f32_16x16x32_bf16 v[220:223], v[92:95], a[28:31], v[220:223]
    ds_read_b64_tr_b16 v[70:71], v3 offset:17408
    v_mfma_f32_16x16x32_bf16 v[96:99], v[32:35], a[0:3], v[96:99]
    ds_read_b128 a[16:19], v7 offset:0
    v_mfma_f32_16x16x32_bf16 v[100:103], v[32:35], a[4:7], v[100:103]
    ds_read_b64_tr_b16 v[72:73], v4 offset:16384
    v_mfma_f32_16x16x32_bf16 v[104:107], v[32:35], a[8:11], v[104:107]
    ds_read_b64_tr_b16 v[74:75], v4 offset:17408
    v_mfma_f32_16x16x32_bf16 v[108:111], v[32:35], a[12:15], v[108:111]
    ds_read_b64_tr_b16 v[76:77], v5 offset:16384
    v_mfma_f32_16x16x32_bf16 v[112:115], v[36:39], a[0:3], v[112:115]
    ds_read_b64_tr_b16 v[78:79], v5 offset:17408
    v_mfma_f32_16x16x32_bf16 v[116:119], v[36:39], a[4:7], v[116:119]
    ds_read_b128 a[20:23], v7 offset:2048
    v_mfma_f32_16x16x32_bf16 v[120:123], v[36:39], a[8:11], v[120:123]
    ds_read_b64_tr_b16 v[80:81], v2 offset:18432
    v_mfma_f32_16x16x32_bf16 v[124:127], v[36:39], a[12:15], v[124:127]
    ds_read_b64_tr_b16 v[82:83], v2 offset:19456
    v_mfma_f32_16x16x32_bf16 v[128:131], v[40:43], a[0:3], v[128:131]
    ds_read_b64_tr_b16 v[84:85], v3 offset:18432
    v_mfma_f32_16x16x32_bf16 v[132:135], v[40:43], a[4:7], v[132:135]
    ds_read_b64_tr_b16 v[86:87], v3 offset:19456
    v_mfma_f32_16x16x32_bf16 v[136:139], v[40:43], a[8:11], v[136:139]
    ds_read_b128 a[24:27], v7 offset:4096
    v_mfma_f32_16x16x32_bf16 v[140:143], v[40:43], a[12:15], v[140:143]
    ds_read_b64_tr_b16 v[88:89], v4 offset:18432
    v_mfma_f32_16x16x32_bf16 v[144:147], v[44:47], a[0:3], v[144:147]
    ds_read_b64_tr_b16 v[90:91], v4 offset:19456
    v_mfma_f32_16x16x32_bf16 v[148:151], v[44:47], a[4:7], v[148:151]
    ds_read_b64_tr_b16 v[92:93], v5 offset:18432
    v_mfma_f32_16x16x32_bf16 v[152:155], v[44:47], a[8:11], v[152:155]
    ds_read_b64_tr_b16 v[94:95], v5 offset:19456
    v_mfma_f32_16x16x32_bf16 v[156:159], v[44:47], a[12:15], v[156:159]
    ds_read_b128 a[28:31], v7 offset:6144
    v_mfma_f32_16x16x32_bf16 v[160:163], v[48:51], a[0:3], v[160:163]
    v_mov_b32 v16, -1
    v_mfma_f32_16x16x32_bf16 v[164:167], v[48:51], a[4:7], v[164:167]
    v_mfma_f32_16x16x32_bf16 v[168:171], v[48:51], a[8:11], v[168:171]
    v_mov_b32 v17, -1
    v_mfma_f32_16x16x32_bf16 v[172:175], v[48:51], a[12:15], v[172:175]
    v_mfma_f32_16x16x32_bf16 v[176:179], v[52:55], a[0:3], v[176:179]
    v_mov_b32 v18, -1
    v_mfma_f32_16x16x32_bf16 v[180:183], v[52:55], a[4:7], v[180:183]
    v_mfma_f32_16x16x32_bf16 v[184:187], v[52:55], a[8:11], v[184:187]
    v_mov_b32 v19, -1
    v_mfma_f32_16x16x32_bf16 v[188:191], v[52:55], a[12:15], v[188:191]
    v_mfma_f32_16x16x32_bf16 v[192:195], v[56:59], a[0:3], v[192:195]
    buffer_store_dwordx4 v[16:19], v24, s[48:51], s77 offen offset:0 sc1
    v_mfma_f32_16x16x32_bf16 v[196:199], v[56:59], a[4:7], v[196:199]
    v_mfma_f32_16x16x32_bf16 v[200:203], v[56:59], a[8:11], v[200:203]
    buffer_store_dwordx4 v[16:19], v24, s[48:51], s77 offen offset:1024 sc1
    v_mfma_f32_16x16x32_bf16 v[204:207], v[56:59], a[12:15], v[204:207]
    s_waitcnt lgkmcnt(0)
    s_barrier
    v_mfma_f32_16x16x32_bf16 v[208:211], v[60:63], a[0:3], v[208:211]
    ds_read_b64_tr_b16 v[32:33], v2 offset:32768
    v_mfma_f32_16x16x32_bf16 v[212:215], v[60:63], a[4:7], v[212:215]
    ds_read_b64_tr_b16 v[34:35], v2 offset:33792
    v_mfma_f32_16x16x32_bf16 v[216:219], v[60:63], a[8:11], v[216:219]
    ds_read_b64_tr_b16 v[36:37], v3 offset:32768
    v_mfma_f32_16x16x32_bf16 v[220:223], v[60:63], a[12:15], v[220:223]
    ds_read_b64_tr_b16 v[38:39], v3 offset:33792
    v_mfma_f32_16x16x32_bf16 v[96:99], v[64:67], a[16:19], v[96:99]
    ds_read_b128 a[0:3], v6 offset:16384
    v_mfma_f32_16x16x32_bf16 v[100:103], v[64:67], a[20:23], v[100:103]
    ds_read_b64_tr_b16 v[40:41], v4 offset:32768
    v_mfma_f32_16x16x32_bf16 v[104:107], v[64:67], a[24:27], v[104:107]
    ds_read_b64_tr_b16 v[42:43], v4 offset:33792
    v_mfma_f32_16x16x32_bf16 v[108:111], v[64:67], a[28:31], v[108:111]
    ds_read_b64_tr_b16 v[44:45], v5 offset:32768
    v_mfma_f32_16x16x32_bf16 v[112:115], v[68:71], a[16:19], v[112:115]
    ds_read_b64_tr_b16 v[46:47], v5 offset:33792
    v_mfma_f32_16x16x32_bf16 v[116:119], v[68:71], a[20:23], v[116:119]
    ds_read_b128 a[4:7], v6 offset:18432
    v_mfma_f32_16x16x32_bf16 v[120:123], v[68:71], a[24:27], v[120:123]
    ds_read_b64_tr_b16 v[48:49], v2 offset:34816
    v_mfma_f32_16x16x32_bf16 v[124:127], v[68:71], a[28:31], v[124:127]
    ds_read_b64_tr_b16 v[50:51], v2 offset:35840
    v_mfma_f32_16x16x32_bf16 v[128:131], v[72:75], a[16:19], v[128:131]
    ds_read_b64_tr_b16 v[52:53], v3 offset:34816
    v_mfma_f32_16x16x32_bf16 v[132:135], v[72:75], a[20:23], v[132:135]
    ds_read_b64_tr_b16 v[54:55], v3 offset:35840
    v_mfma_f32_16x16x32_bf16 v[136:139], v[72:75], a[24:27], v[136:139]
    ds_read_b128 a[8:11], v6 offset:20480
    v_mfma_f32_16x16x32_bf16 v[140:143], v[72:75], a[28:31], v[140:143]
    ds_read_b64_tr_b16 v[56:57], v4 offset:34816
    v_mfma_f32_16x16x32_bf16 v[144:147], v[76:79], a[16:19], v[144:147]
    ds_read_b64_tr_b16 v[58:59], v4 offset:35840
    v_mfma_f32_16x16x32_bf16 v[148:151], v[76:79], a[20:23], v[148:151]
    ds_read_b64_tr_b16 v[60:61], v5 offset:34816
    v_mfma_f32_16x16x32_bf16 v[152:155], v[76:79], a[24:27], v[152:155]
    ds_read_b64_tr_b16 v[62:63], v5 offset:35840
    v_mfma_f32_16x16x32_bf16 v[156:159], v[76:79], a[28:31], v[156:159]
    ds_read_b128 a[12:15], v6 offset:22528
    v_mfma_f32_16x16x32_bf16 v[160:163], v[80:83], a[16:19], v[160:163]
    v_mfma_f32_16x16x32_bf16 v[164:167], v[80:83], a[20:23], v[164:167]
    v_mfma_f32_16x16x32_bf16 v[168:171], v[80:83], a[24:27], v[168:171]
    v_mfma_f32_16x16x32_bf16 v[172:175], v[80:83], a[28:31], v[172:175]
    v_mfma_f32_16x16x32_bf16 v[176:179], v[84:87], a[16:19], v[176:179]
    v_mfma_f32_16x16x32_bf16 v[180:183], v[84:87], a[20:23], v[180:183]
    v_mfma_f32_16x16x32_bf16 v[184:187], v[84:87], a[24:27], v[184:187]
    v_mfma_f32_16x16x32_bf16 v[188:191], v[84:87], a[28:31], v[188:191]
    v_mfma_f32_16x16x32_bf16 v[192:195], v[88:91], a[16:19], v[192:195]
    v_mfma_f32_16x16x32_bf16 v[196:199], v[88:91], a[20:23], v[196:199]
    v_mfma_f32_16x16x32_bf16 v[200:203], v[88:91], a[24:27], v[200:203]
    v_mfma_f32_16x16x32_bf16 v[204:207], v[88:91], a[28:31], v[204:207]
    s_waitcnt lgkmcnt(0)
    v_mfma_f32_16x16x32_bf16 v[208:211], v[92:95], a[16:19], v[208:211]
    ds_read_b64_tr_b16 v[64:65], v2 offset:49152
    v_mfma_f32_16x16x32_bf16 v[212:215], v[92:95], a[20:23], v[212:215]
    ds_read_b64_tr_b16 v[66:67], v2 offset:50176
    v_mfma_f32_16x16x32_bf16 v[216:219], v[92:95], a[24:27], v[216:219]
    ds_read_b64_tr_b16 v[68:69], v3 offset:49152
    v_mfma_f32_16x16x32_bf16 v[220:223], v[92:95], a[28:31], v[220:223]
    ds_read_b64_tr_b16 v[70:71], v3 offset:50176
    v_mfma_f32_16x16x32_bf16 v[96:99], v[32:35], a[0:3], v[96:99]
    ds_read_b128 a[16:19], v7 offset:16384
    v_mfma_f32_16x16x32_bf16 v[100:103], v[32:35], a[4:7], v[100:103]
    ds_read_b64_tr_b16 v[72:73], v4 offset:49152
    v_mfma_f32_16x16x32_bf16 v[104:107], v[32:35], a[8:11], v[104:107]
    ds_read_b64_tr_b16 v[74:75], v4 offset:50176
    v_mfma_f32_16x16x32_bf16 v[108:111], v[32:35], a[12:15], v[108:111]
    ds_read_b64_tr_b16 v[76:77], v5 offset:49152
    v_mfma_f32_16x16x32_bf16 v[112:115], v[36:39], a[0:3], v[112:115]
    ds_read_b64_tr_b16 v[78:79], v5 offset:50176
    v_mfma_f32_16x16x32_bf16 v[116:119], v[36:39], a[4:7], v[116:119]
    ds_read_b128 a[20:23], v7 offset:18432
    v_mfma_f32_16x16x32_bf16 v[120:123], v[36:39], a[8:11], v[120:123]
    ds_read_b64_tr_b16 v[80:81], v2 offset:51200
    v_mfma_f32_16x16x32_bf16 v[124:127], v[36:39], a[12:15], v[124:127]
    ds_read_b64_tr_b16 v[82:83], v2 offset:52224
    v_mfma_f32_16x16x32_bf16 v[128:131], v[40:43], a[0:3], v[128:131]
    ds_read_b64_tr_b16 v[84:85], v3 offset:51200
    v_mfma_f32_16x16x32_bf16 v[132:135], v[40:43], a[4:7], v[132:135]
    ds_read_b64_tr_b16 v[86:87], v3 offset:52224
    v_mfma_f32_16x16x32_bf16 v[136:139], v[40:43], a[8:11], v[136:139]
    ds_read_b128 a[24:27], v7 offset:20480
    v_mfma_f32_16x16x32_bf16 v[140:143], v[40:43], a[12:15], v[140:143]
    ds_read_b64_tr_b16 v[88:89], v4 offset:51200
    v_mfma_f32_16x16x32_bf16 v[144:147], v[44:47], a[0:3], v[144:147]
    ds_read_b64_tr_b16 v[90:91], v4 offset:52224
    v_mfma_f32_16x16x32_bf16 v[148:151], v[44:47], a[4:7], v[148:151]
    ds_read_b64_tr_b16 v[92:93], v5 offset:51200
    v_mfma_f32_16x16x32_bf16 v[152:155], v[44:47], a[8:11], v[152:155]
    ds_read_b64_tr_b16 v[94:95], v5 offset:52224
    v_mfma_f32_16x16x32_bf16 v[156:159], v[44:47], a[12:15], v[156:159]
    ds_read_b128 a[28:31], v7 offset:22528
    v_mfma_f32_16x16x32_bf16 v[160:163], v[48:51], a[0:3], v[160:163]
    v_mfma_f32_16x16x32_bf16 v[164:167], v[48:51], a[4:7], v[164:167]
    v_lshrrev_b32 v28, 4, v1
    v_mfma_f32_16x16x32_bf16 v[168:171], v[48:51], a[8:11], v[168:171]
    s_lshl_b32 s92, s82, 8
    v_mfma_f32_16x16x32_bf16 v[172:175], v[48:51], a[12:15], v[172:175]
    s_add_u32 s92, s92, 158208
    v_mfma_f32_16x16x32_bf16 v[176:179], v[52:55], a[0:3], v[176:179]
    v_lshl_add_u32 v28, v28, 4, s92
    v_mfma_f32_16x16x32_bf16 v[180:183], v[52:55], a[4:7], v[180:183]
    v_and_b32 v29, 15, v1
    v_mfma_f32_16x16x32_bf16 v[184:187], v[52:55], a[8:11], v[184:187]
    s_lshl_b32 s92, s81, 10
    v_mfma_f32_16x16x32_bf16 v[188:191], v[52:55], a[12:15], v[188:191]
    s_add_u32 s92, s92, 159232
    v_mfma_f32_16x16x32_bf16 v[192:195], v[56:59], a[0:3], v[192:195]
    v_lshl_add_u32 v29, v29, 4, s92
    v_mfma_f32_16x16x32_bf16 v[196:199], v[56:59], a[4:7], v[196:199]
    v_mfma_f32_16x16x32_bf16 v[200:203], v[56:59], a[8:11], v[200:203]
    v_mfma_f32_16x16x32_bf16 v[204:207], v[56:59], a[12:15], v[204:207]
    s_waitcnt lgkmcnt(0)
    v_mfma_f32_16x16x32_bf16 v[208:211], v[60:63], a[0:3], v[208:211]
    v_mfma_f32_16x16x32_bf16 v[212:215], v[60:63], a[4:7], v[212:215]
    v_mov_b32 v8, s89
    v_lshl_add_u32 v9, s80, 2, v0
    ds_write_b32 v9, v8 offset:16
    v_mfma_f32_16x16x32_bf16 v[216:219], v[60:63], a[8:11], v[216:219]
    v_mfma_f32_16x16x32_bf16 v[220:223], v[60:63], a[12:15], v[220:223]
    v_mfma_f32_16x16x32_bf16 v[96:99], v[64:67], a[16:19], v[96:99]
    v_mfma_f32_16x16x32_bf16 v[100:103], v[64:67], a[20:23], v[100:103]
    v_mfma_f32_16x16x32_bf16 v[104:107], v[64:67], a[24:27], v[104:107]
    v_mfma_f32_16x16x32_bf16 v[108:111], v[64:67], a[28:31], v[108:111]
    v_mfma_f32_16x16x32_bf16 v[112:115], v[68:71], a[16:19], v[112:115]
    v_mfma_f32_16x16x32_bf16 v[116:119], v[68:71], a[20:23], v[116:119]
    v_mfma_f32_16x16x32_bf16 v[120:123], v[68:71], a[24:27], v[120:123]
    v_mfma_f32_16x16x32_bf16 v[124:127], v[68:71], a[28:31], v[124:127]
    v_mfma_f32_16x16x32_bf16 v[128:131], v[72:75], a[16:19], v[128:131]
    v_mfma_f32_16x16x32_bf16 v[132:135], v[72:75], a[20:23], v[132:135]
    v_mfma_f32_16x16x32_bf16 v[136:139], v[72:75], a[24:27], v[136:139]
    v_mfma_f32_16x16x32_bf16 v[140:143], v[72:75], a[28:31], v[140:143]
    v_mfma_f32_16x16x32_bf16 v[144:147], v[76:79], a[16:19], v[144:147]
    v_mfma_f32_16x16x32_bf16 v[148:151], v[76:79], a[20:23], v[148:151]
    ds_read_b128 v[12:15], v0 offset:0
    v_mfma_f32_16x16x32_bf16 v[152:155], v[76:79], a[24:27], v[152:155]
    v_mfma_f32_16x16x32_bf16 v[156:159], v[76:79], a[28:31], v[156:159]
    v_mfma_f32_16x16x32_bf16 v[160:163], v[80:83], a[16:19], v[160:163]
    v_mfma_f32_16x16x32_bf16 v[164:167], v[80:83], a[20:23], v[164:167]
    v_mfma_f32_16x16x32_bf16 v[168:171], v[80:83], a[24:27], v[168:171]
    v_mfma_f32_16x16x32_bf16 v[172:175], v[80:83], a[28:31], v[172:175]
    v_mfma_f32_16x16x32_bf16 v[176:179], v[84:87], a[16:19], v[176:179]
    s_waitcnt lgkmcnt(0)
LB_32:
    v_xor_b32 v12, s89, v12
    v_xor_b32 v13, s89, v13
    v_xor_b32 v14, s89, v14
    v_xor_b32 v15, s89, v15
    v_or3_b32 v13, v13, v14, v15
    v_or_b32 v12, v12, v13
    v_cmp_ne_u32 vcc, 0, v12
    s_nop 0
    s_cbranch_vccnz LS_31
LO_33:
    v_mfma_f32_16x16x32_bf16 v[180:183], v[84:87], a[20:23], v[180:183]
    ds_read_b128 v[8:11], v29 offset:0
    ds_read_b128 v[12:15], v29 offset:256
    v_mfma_f32_16x16x32_bf16 v[184:187], v[84:87], a[24:27], v[184:187]
    ds_read_b128 v[16:19], v29 offset:512
    ds_read_b128 v[20:23], v29 offset:768
    v_mfma_f32_16x16x32_bf16 v[188:191], v[84:87], a[28:31], v[188:191]
    ds_read_b128 v[32:35], v28 offset:0
    ds_read_b128 v[36:39], v28 offset:64
    v_mfma_f32_16x16x32_bf16 v[192:195], v[88:91], a[16:19], v[192:195]
    ds_read_b128 v[40:43], v28 offset:128
    ds_read_b128 v[44:47], v28 offset:192
    v_mfma_f32_16x16x32_bf16 v[196:199], v[88:91], a[20:23], v[196:199]
    ds_read_b128 v[48:51], v28 offset:512
    ds_read_b128 v[52:55], v28 offset:576
    v_mfma_f32_16x16x32_bf16 v[200:203], v[88:91], a[24:27], v[200:203]
    ds_read_b128 v[56:59], v28 offset:640
    ds_read_b128 v[60:63], v28 offset:704
    v_mfma_f32_16x16x32_bf16 v[204:207], v[88:91], a[28:31], v[204:207]
    v_mfma_f32_16x16x32_bf16 v[208:211], v[92:95], a[16:19], v[208:211]
    v_mfma_f32_16x16x32_bf16 v[212:215], v[92:95], a[20:23], v[212:215]
    v_mfma_f32_16x16x32_bf16 v[216:219], v[92:95], a[24:27], v[216:219]
    v_mfma_f32_16x16x32_bf16 v[220:223], v[92:95], a[28:31], v[220:223]
    s_waitcnt lgkmcnt(0)
    s_nop 6
    v_pk_fma_f32 v[96:97], v[32:33], v[8:9], v[96:97] op_sel_hi:[1,0,1]
    v_pk_fma_f32 v[98:99], v[34:35], v[8:9], v[98:99] op_sel_hi:[1,0,1]
    v_pk_mul_f32 v[64:65], v[96:97], v[8:9] op_sel:[0,1] op_sel_hi:[1,1]
    v_pk_mul_f32 v[66:67], v[98:99], v[8:9] op_sel:[0,1] op_sel_hi:[1,1]
    v_exp_f32 v64, v64
    v_exp_f32 v65, v65
    v_exp_f32 v66, v66
    v_exp_f32 v67, v67
    v_pk_fma_f32 v[160:161], v[48:49], v[8:9], v[160:161] op_sel_hi:[1,0,1]
    v_pk_fma_f32 v[162:163], v[50:51], v[8:9], v[162:163] op_sel_hi:[1,0,1]
    v_pk_fma_f32 v[64:65], v[64:65], v[10:11], v[10:11] op_sel_hi:[1,0,0]
    v_pk_fma_f32 v[66:67], v[66:67], v[10:11], v[10:11] op_sel_hi:[1,0,0]
    v_rcp_f32 v64, v64
    v_rcp_f32 v65, v65
    v_rcp_f32 v66, v66
    v_rcp_f32 v67, v67
    v_pk_mul_f32 v[96:97], v[96:97], v[160:161]
    v_pk_mul_f32 v[98:99], v[98:99], v[162:163]
    v_pk_mul_f32 v[96:97], v[96:97], v[64:65]
    v_pk_mul_f32 v[98:99], v[98:99], v[66:67]
    v_cvt_pk_bf16_f32 v72, v96, v97
    v_cvt_pk_bf16_f32 v73, v98, v99
    v_pk_fma_f32 v[112:113], v[36:37], v[8:9], v[112:113] op_sel_hi:[1,0,1]
    v_pk_fma_f32 v[114:115], v[38:39], v[8:9], v[114:115] op_sel_hi:[1,0,1]
    v_pk_mul_f32 v[64:65], v[112:113], v[8:9] op_sel:[0,1] op_sel_hi:[1,1]
    v_pk_mul_f32 v[66:67], v[114:115], v[8:9] op_sel:[0,1] op_sel_hi:[1,1]
    v_exp_f32 v64, v64
    v_exp_f32 v65, v65
    v_exp_f32 v66, v66
    v_exp_f32 v67, v67
    v_pk_fma_f32 v[176:177], v[52:53], v[8:9], v[176:177] op_sel_hi:[1,0,1]
    v_pk_fma_f32 v[178:179], v[54:55], v[8:9], v[178:179] op_sel_hi:[1,0,1]
    v_pk_fma_f32 v[64:65], v[64:65], v[10:11], v[10:11] op_sel_hi:[1,0,0]
    v_pk_fma_f32 v[66:67], v[66:67], v[10:11], v[10:11] op_sel_hi:[1,0,0]
    v_rcp_f32 v64, v64
    v_rcp_f32 v65, v65
    v_rcp_f32 v66, v66
    v_rcp_f32 v67, v67
    v_pk_mul_f32 v[112:113], v[112:113], v[176:177]
    v_pk_mul_f32 v[114:115], v[114:115], v[178:179]
    v_pk_mul_f32 v[112:113], v[112:113], v[64:65]
    v_pk_mul_f32 v[114:115], v[114:115], v[66:67]
    v_cvt_pk_bf16_f32 v74, v112, v113
    v_cvt_pk_bf16_f32 v75, v114, v115
    s_waitcnt vmcnt(0)
    v_mov_b32 v27, s89
    s_mov_b64 exec, 1
    buffer_store_dword v27, off, s[48:51], s78 sc1
    s_mov_b64 exec, -1
    buffer_store_dwordx4 v[72:75], v24, s[48:51], s37 offen offset:0 sc1
    v_pk_fma_f32 v[128:129], v[40:41], v[8:9], v[128:129] op_sel_hi:[1,0,1]
    v_pk_fma_f32 v[130:131], v[42:43], v[8:9], v[130:131] op_sel_hi:[1,0,1]
    v_pk_mul_f32 v[64:65], v[128:129], v[8:9] op_sel:[0,1] op_sel_hi:[1,1]
    v_pk_mul_f32 v[66:67], v[130:131], v[8:9] op_sel:[0,1] op_sel_hi:[1,1]
    v_exp_f32 v64, v64
    v_exp_f32 v65, v65
    v_exp_f32 v66, v66
    v_exp_f32 v67, v67
    v_pk_fma_f32 v[192:193], v[56:57], v[8:9], v[192:193] op_sel_hi:[1,0,1]
    v_pk_fma_f32 v[194:195], v[58:59], v[8:9], v[194:195] op_sel_hi:[1,0,1]
    v_pk_fma_f32 v[64:65], v[64:65], v[10:11], v[10:11] op_sel_hi:[1,0,0]
    v_pk_fma_f32 v[66:67], v[66:67], v[10:11], v[10:11] op_sel_hi:[1,0,0]
    v_rcp_f32 v64, v64
    v_rcp_f32 v65, v65
    v_rcp_f32 v66, v66
    v_rcp_f32 v67, v67
    v_pk_mul_f32 v[128:129], v[128:129], v[192:193]
    v_pk_mul_f32 v[130:131], v[130:131], v[194:195]
    v_pk_mul_f32 v[128:129], v[128:129], v[64:65]
    v_pk_mul_f32 v[130:131], v[130:131], v[66:67]
    v_cvt_pk_bf16_f32 v76, v128, v129
    v_cvt_pk_bf16_f32 v77, v130, v131
    v_pk_fma_f32 v[144:145], v[44:45], v[8:9], v[144:145] op_sel_hi:[1,0,1]
    v_pk_fma_f32 v[146:147], v[46:47], v[8:9], v[146:147] op_sel_hi:[1,0,1]
    v_pk_mul_f32 v[64:65], v[144:145], v[8:9] op_sel:[0,1] op_sel_hi:[1,1]
    v_pk_mul_f32 v[66:67], v[146:147], v[8:9] op_sel:[0,1] op_sel_hi:[1,1]
    v_exp_f32 v64, v64
    v_exp_f32 v65, v65
    v_exp_f32 v66, v66
    v_exp_f32 v67, v67
    v_pk_fma_f32 v[208:209], v[60:61], v[8:9], v[208:209] op_sel_hi:[1,0,1]
    v_pk_fma_f32 v[210:211], v[62:63], v[8:9], v[210:211] op_sel_hi:[1,0,1]
    v_pk_fma_f32 v[64:65], v[64:65], v[10:11], v[10:11] op_sel_hi:[1,0,0]
    v_pk_fma_f32 v[66:67], v[66:67], v[10:11], v[10:11] op_sel_hi:[1,0,0]
    v_rcp_f32 v64, v64
    v_rcp_f32 v65, v65
    v_rcp_f32 v66, v66
    v_rcp_f32 v67, v67
    v_pk_mul_f32 v[144:145], v[144:145], v[208:209]
    v_pk_mul_f32 v[146:147], v[146:147], v[210:211]
    v_pk_mul_f32 v[144:145], v[144:145], v[64:65]
    v_pk_mul_f32 v[146:147], v[146:147], v[66:67]
    v_cvt_pk_bf16_f32 v78, v144, v145
    v_cvt_pk_bf16_f32 v79, v146, v147
    buffer_store_dwordx4 v[76:79], v24, s[48:51], s37 offen offset:1024 sc1
    v_pk_fma_f32 v[100:101], v[32:33], v[12:13], v[100:101] op_sel_hi:[1,0,1]
    v_pk_fma_f32 v[102:103], v[34:35], v[12:13], v[102:103] op_sel_hi:[1,0,1]
    v_pk_mul_f32 v[64:65], v[100:101], v[12:13] op_sel:[0,1] op_sel_hi:[1,1]
    v_pk_mul_f32 v[66:67], v[102:103], v[12:13] op_sel:[0,1] op_sel_hi:[1,1]
    v_exp_f32 v64, v64
    v_exp_f32 v65, v65
    v_exp_f32 v66, v66
    v_exp_f32 v67, v67
    v_pk_fma_f32 v[164:165], v[48:49], v[12:13], v[164:165] op_sel_hi:[1,0,1]
    v_pk_fma_f32 v[166:167], v[50:51], v[12:13], v[166:167] op_sel_hi:[1,0,1]
    v_pk_fma_f32 v[64:65], v[64:65], v[14:15], v[14:15] op_sel_hi:[1,0,0]
    v_pk_fma_f32 v[66:67], v[66:67], v[14:15], v[14:15] op_sel_hi:[1,0,0]
    v_rcp_f32 v64, v64
    v_rcp_f32 v65, v65
    v_rcp_f32 v66, v66
    v_rcp_f32 v67, v67
    v_pk_mul_f32 v[100:101], v[100:101], v[164:165]
    v_pk_mul_f32 v[102:103], v[102:103], v[166:167]
    v_pk_mul_f32 v[100:101], v[100:101], v[64:65]
    v_pk_mul_f32 v[102:103], v[102:103], v[66:67]
    v_cvt_pk_bf16_f32 v72, v100, v101
    v_cvt_pk_bf16_f32 v73, v102, v103
    v_pk_fma_f32 v[116:117], v[36:37], v[12:13], v[116:117] op_sel_hi:[1,0,1]
    v_pk_fma_f32 v[118:119], v[38:39], v[12:13], v[118:119] op_sel_hi:[1,0,1]
    v_pk_mul_f32 v[64:65], v[116:117], v[12:13] op_sel:[0,1] op_sel_hi:[1,1]
    v_pk_mul_f32 v[66:67], v[118:119], v[12:13] op_sel:[0,1] op_sel_hi:[1,1]
    v_exp_f32 v64, v64
    v_exp_f32 v65, v65
    v_exp_f32 v66, v66
    v_exp_f32 v67, v67
    v_pk_fma_f32 v[180:181], v[52:53], v[12:13], v[180:181] op_sel_hi:[1,0,1]
    v_pk_fma_f32 v[182:183], v[54:55], v[12:13], v[182:183] op_sel_hi:[1,0,1]
    v_pk_fma_f32 v[64:65], v[64:65], v[14:15], v[14:15] op_sel_hi:[1,0,0]
    v_pk_fma_f32 v[66:67], v[66:67], v[14:15], v[14:15] op_sel_hi:[1,0,0]
    v_rcp_f32 v64, v64
    v_rcp_f32 v65, v65
    v_rcp_f32 v66, v66
    v_rcp_f32 v67, v67
    v_pk_mul_f32 v[116:117], v[116:117], v[180:181]
    v_pk_mul_f32 v[118:119], v[118:119], v[182:183]
    v_pk_mul_f32 v[116:117], v[116:117], v[64:65]
    v_pk_mul_f32 v[118:119], v[118:119], v[66:67]
    v_cvt_pk_bf16_f32 v74, v116, v117
    v_cvt_pk_bf16_f32 v75, v118, v119
    s_add_u32 s37, s37, 57344
    buffer_store_dwordx4 v[72:75], v24, s[48:51], s37 offen offset:0 sc1
    v_pk_fma_f32 v[132:133], v[40:41], v[12:13], v[132:133] op_sel_hi:[1,0,1]
    v_pk_fma_f32 v[134:135], v[42:43], v[12:13], v[134:135] op_sel_hi:[1,0,1]
    v_pk_mul_f32 v[64:65], v[132:133], v[12:13] op_sel:[0,1] op_sel_hi:[1,1]
    v_pk_mul_f32 v[66:67], v[134:135], v[12:13] op_sel:[0,1] op_sel_hi:[1,1]
    v_exp_f32 v64, v64
    v_exp_f32 v65, v65
    v_exp_f32 v66, v66
    v_exp_f32 v67, v67
    v_pk_fma_f32 v[196:197], v[56:57], v[12:13], v[196:197] op_sel_hi:[1,0,1]
    v_pk_fma_f32 v[198:199], v[58:59], v[12:13], v[198:199] op_sel_hi:[1,0,1]
    v_pk_fma_f32 v[64:65], v[64:65], v[14:15], v[14:15] op_sel_hi:[1,0,0]
    v_pk_fma_f32 v[66:67], v[66:67], v[14:15], v[14:15] op_sel_hi:[1,0,0]
    v_rcp_f32 v64, v64
    v_rcp_f32 v65, v65
    v_rcp_f32 v66, v66
    v_rcp_f32 v67, v67
    v_pk_mul_f32 v[132:133], v[132:133], v[196:197]
    v_pk_mul_f32 v[134:135], v[134:135], v[198:199]
    v_pk_mul_f32 v[132:133], v[132:133], v[64:65]
    v_pk_mul_f32 v[134:135], v[134:135], v[66:67]
    v_cvt_pk_bf16_f32 v76, v132, v133
    v_cvt_pk_bf16_f32 v77, v134, v135
    v_pk_fma_f32 v[148:149], v[44:45], v[12:13], v[148:149] op_sel_hi:[1,0,1]
    v_pk_fma_f32 v[150:151], v[46:47], v[12:13], v[150:151] op_sel_hi:[1,0,1]
    v_pk_mul_f32 v[64:65], v[148:149], v[12:13] op_sel:[0,1] op_sel_hi:[1,1]
    v_pk_mul_f32 v[66:67], v[150:151], v[12:13] op_sel:[0,1] op_sel_hi:[1,1]
    v_exp_f32 v64, v64
    v_exp_f32 v65, v65
    v_exp_f32 v66, v66
    v_exp_f32 v67, v67
    v_pk_fma_f32 v[212:213], v[60:61], v[12:13], v[212:213] op_sel_hi:[1,0,1]
    v_pk_fma_f32 v[214:215], v[62:63], v[12:13], v[214:215] op_sel_hi:[1,0,1]
    v_pk_fma_f32 v[64:65], v[64:65], v[14:15], v[14:15] op_sel_hi:[1,0,0]
    v_pk_fma_f32 v[66:67], v[66:67], v[14:15], v[14:15] op_sel_hi:[1,0,0]
    v_rcp_f32 v64, v64
    v_rcp_f32 v65, v65
    v_rcp_f32 v66, v66
    v_rcp_f32 v67, v67
    v_pk_mul_f32 v[148:149], v[148:149], v[212:213]
    v_pk_mul_f32 v[150:151], v[150:151], v[214:215]
    v_pk_mul_f32 v[148:149], v[148:149], v[64:65]
    v_pk_mul_f32 v[150:151], v[150:151], v[66:67]
    v_cvt_pk_bf16_f32 v78, v148, v149
    v_cvt_pk_bf16_f32 v79, v150, v151
    buffer_store_dwordx4 v[76:79], v24, s[48:51], s37 offen offset:1024 sc1
    v_pk_fma_f32 v[104:105], v[32:33], v[16:17], v[104:105] op_sel_hi:[1,0,1]
    v_pk_fma_f32 v[106:107], v[34:35], v[16:17], v[106:107] op_sel_hi:[1,0,1]
    v_pk_mul_f32 v[64:65], v[104:105], v[16:17] op_sel:[0,1] op_sel_hi:[1,1]
    v_pk_mul_f32 v[66:67], v[106:107], v[16:17] op_sel:[0,1] op_sel_hi:[1,1]
    v_exp_f32 v64, v64
    v_exp_f32 v65, v65
    v_exp_f32 v66, v66
    v_exp_f32 v67, v67
    v_pk_fma_f32 v[168:169], v[48:49], v[16:17], v[168:169] op_sel_hi:[1,0,1]
    v_pk_fma_f32 v[170:171], v[50:51], v[16:17], v[170:171] op_sel_hi:[1,0,1]
    v_pk_fma_f32 v[64:65], v[64:65], v[18:19], v[18:19] op_sel_hi:[1,0,0]
    v_pk_fma_f32 v[66:67], v[66:67], v[18:19], v[18:19] op_sel_hi:[1,0,0]
    v_rcp_f32 v64, v64
    v_rcp_f32 v65, v65
    v_rcp_f32 v66, v66
    v_rcp_f32 v67, v67
    v_pk_mul_f32 v[104:105], v[104:105], v[168:169]
    v_pk_mul_f32 v[106:107], v[106:107], v[170:171]
    v_pk_mul_f32 v[104:105], v[104:105], v[64:65]
    v_pk_mul_f32 v[106:107], v[106:107], v[66:67]
    v_cvt_pk_bf16_f32 v72, v104, v105
    v_cvt_pk_bf16_f32 v73, v106, v107
    v_pk_fma_f32 v[120:121], v[36:37], v[16:17], v[120:121] op_sel_hi:[1,0,1]
    v_pk_fma_f32 v[122:123], v[38:39], v[16:17], v[122:123] op_sel_hi:[1,0,1]
    v_pk_mul_f32 v[64:65], v[120:121], v[16:17] op_sel:[0,1] op_sel_hi:[1,1]
    v_pk_mul_f32 v[66:67], v[122:123], v[16:17] op_sel:[0,1] op_sel_hi:[1,1]
    v_exp_f32 v64, v64
    v_exp_f32 v65, v65
    v_exp_f32 v66, v66
    v_exp_f32 v67, v67
    v_pk_fma_f32 v[184:185], v[52:53], v[16:17], v[184:185] op_sel_hi:[1,0,1]
    v_pk_fma_f32 v[186:187], v[54:55], v[16:17], v[186:187] op_sel_hi:[1,0,1]
    v_pk_fma_f32 v[64:65], v[64:65], v[18:19], v[18:19] op_sel_hi:[1,0,0]
    v_pk_fma_f32 v[66:67], v[66:67], v[18:19], v[18:19] op_sel_hi:[1,0,0]
    v_rcp_f32 v64, v64
    v_rcp_f32 v65, v65
    v_rcp_f32 v66, v66
    v_rcp_f32 v67, v67
    v_pk_mul_f32 v[120:121], v[120:121], v[184:185]
    v_pk_mul_f32 v[122:123], v[122:123], v[186:187]
    v_pk_mul_f32 v[120:121], v[120:121], v[64:65]
    v_pk_mul_f32 v[122:123], v[122:123], v[66:67]
    v_cvt_pk_bf16_f32 v74, v120, v121
    v_cvt_pk_bf16_f32 v75, v122, v123
    s_add_u32 s37, s37, 57344
    buffer_store_dwordx4 v[72:75], v24, s[48:51], s37 offen offset:0 sc1
    v_pk_fma_f32 v[136:137], v[40:41], v[16:17], v[136:137] op_sel_hi:[1,0,1]
    v_pk_fma_f32 v[138:139], v[42:43], v[16:17], v[138:139] op_sel_hi:[1,0,1]
    v_pk_mul_f32 v[64:65], v[136:137], v[16:17] op_sel:[0,1] op_sel_hi:[1,1]
    v_pk_mul_f32 v[66:67], v[138:139], v[16:17] op_sel:[0,1] op_sel_hi:[1,1]
    v_exp_f32 v64, v64
    v_exp_f32 v65, v65
    v_exp_f32 v66, v66
    v_exp_f32 v67, v67
    v_pk_fma_f32 v[200:201], v[56:57], v[16:17], v[200:201] op_sel_hi:[1,0,1]
    v_pk_fma_f32 v[202:203], v[58:59], v[16:17], v[202:203] op_sel_hi:[1,0,1]
    v_pk_fma_f32 v[64:65], v[64:65], v[18:19], v[18:19] op_sel_hi:[1,0,0]
    v_pk_fma_f32 v[66:67], v[66:67], v[18:19], v[18:19] op_sel_hi:[1,0,0]
    v_rcp_f32 v64, v64
    v_rcp_f32 v65, v65
    v_rcp_f32 v66, v66
    v_rcp_f32 v67, v67
    v_pk_mul_f32 v[136:137], v[136:137], v[200:201]
    v_pk_mul_f32 v[138:139], v[138:139], v[202:203]
    v_pk_mul_f32 v[136:137], v[136:137], v[64:65]
    v_pk_mul_f32 v[138:139], v[138:139], v[66:67]
    v_cvt_pk_bf16_f32 v76, v136, v137
    v_cvt_pk_bf16_f32 v77, v138, v139
    v_pk_fma_f32 v[152:153], v[44:45], v[16:17], v[152:153] op_sel_hi:[1,0,1]
    v_pk_fma_f32 v[154:155], v[46:47], v[16:17], v[154:155] op_sel_hi:[1,0,1]
    v_pk_mul_f32 v[64:65], v[152:153], v[16:17] op_sel:[0,1] op_sel_hi:[1,1]
    v_pk_mul_f32 v[66:67], v[154:155], v[16:17] op_sel:[0,1] op_sel_hi:[1,1]
    v_exp_f32 v64, v64
    v_exp_f32 v65, v65
    v_exp_f32 v66, v66
    v_exp_f32 v67, v67
    v_pk_fma_f32 v[216:217], v[60:61], v[16:17], v[216:217] op_sel_hi:[1,0,1]
    v_pk_fma_f32 v[218:219], v[62:63], v[16:17], v[218:219] op_sel_hi:[1,0,1]
    v_pk_fma_f32 v[64:65], v[64:65], v[18:19], v[18:19] op_sel_hi:[1,0,0]
    v_pk_fma_f32 v[66:67], v[66:67], v[18:19], v[18:19] op_sel_hi:[1,0,0]
    v_rcp_f32 v64, v64
    v_rcp_f32 v65, v65
    v_rcp_f32 v66, v66
    v_rcp_f32 v67, v67
    v_pk_mul_f32 v[152:153], v[152:153], v[216:217]
    v_pk_mul_f32 v[154:155], v[154:155], v[218:219]
    v_pk_mul_f32 v[152:153], v[152:153], v[64:65]
    v_pk_mul_f32 v[154:155], v[154:155], v[66:67]
    v_cvt_pk_bf16_f32 v78, v152, v153
    v_cvt_pk_bf16_f32 v79, v154, v155
    buffer_store_dwordx4 v[76:79], v24, s[48:51], s37 offen offset:1024 sc1
    v_pk_fma_f32 v[108:109], v[32:33], v[20:21], v[108:109] op_sel_hi:[1,0,1]
    v_pk_fma_f32 v[110:111], v[34:35], v[20:21], v[110:111] op_sel_hi:[1,0,1]
    v_pk_mul_f32 v[64:65], v[108:109], v[20:21] op_sel:[0,1] op_sel_hi:[1,1]
    v_pk_mul_f32 v[66:67], v[110:111], v[20:21] op_sel:[0,1] op_sel_hi:[1,1]
    v_exp_f32 v64, v64
    v_exp_f32 v65, v65
    v_exp_f32 v66, v66
    v_exp_f32 v67, v67
    v_pk_fma_f32 v[172:173], v[48:49], v[20:21], v[172:173] op_sel_hi:[1,0,1]
    v_pk_fma_f32 v[174:175], v[50:51], v[20:21], v[174:175] op_sel_hi:[1,0,1]
    v_pk_fma_f32 v[64:65], v[64:65], v[22:23], v[22:23] op_sel_hi:[1,0,0]
    v_pk_fma_f32 v[66:67], v[66:67], v[22:23], v[22:23] op_sel_hi:[1,0,0]
    v_rcp_f32 v64, v64
    v_rcp_f32 v65, v65
    v_rcp_f32 v66, v66
    v_rcp_f32 v67, v67
    v_pk_mul_f32 v[108:109], v[108:109], v[172:173]
    v_pk_mul_f32 v[110:111], v[110:111], v[174:175]
    v_pk_mul_f32 v[108:109], v[108:109], v[64:65]
    v_pk_mul_f32 v[110:111], v[110:111], v[66:67]
    v_cvt_pk_bf16_f32 v72, v108, v109
    v_cvt_pk_bf16_f32 v73, v110, v111
    v_pk_fma_f32 v[124:125], v[36:37], v[20:21], v[124:125] op_sel_hi:[1,0,1]
    v_pk_fma_f32 v[126:127], v[38:39], v[20:21], v[126:127] op_sel_hi:[1,0,1]
    v_pk_mul_f32 v[64:65], v[124:125], v[20:21] op_sel:[0,1] op_sel_hi:[1,1]
    v_pk_mul_f32 v[66:67], v[126:127], v[20:21] op_sel:[0,1] op_sel_hi:[1,1]
    v_exp_f32 v64, v64
    v_exp_f32 v65, v65
    v_exp_f32 v66, v66
    v_exp_f32 v67, v67
    v_pk_fma_f32 v[188:189], v[52:53], v[20:21], v[188:189] op_sel_hi:[1,0,1]
    v_pk_fma_f32 v[190:191], v[54:55], v[20:21], v[190:191] op_sel_hi:[1,0,1]
    v_pk_fma_f32 v[64:65], v[64:65], v[22:23], v[22:23] op_sel_hi:[1,0,0]
    v_pk_fma_f32 v[66:67], v[66:67], v[22:23], v[22:23] op_sel_hi:[1,0,0]
    v_rcp_f32 v64, v64
    v_rcp_f32 v65, v65
    v_rcp_f32 v66, v66
    v_rcp_f32 v67, v67
    v_pk_mul_f32 v[124:125], v[124:125], v[188:189]
    v_pk_mul_f32 v[126:127], v[126:127], v[190:191]
    v_pk_mul_f32 v[124:125], v[124:125], v[64:65]
    v_pk_mul_f32 v[126:127], v[126:127], v[66:67]
    v_cvt_pk_bf16_f32 v74, v124, v125
    v_cvt_pk_bf16_f32 v75, v126, v127
    s_add_u32 s37, s37, 57344
    buffer_store_dwordx4 v[72:75], v24, s[48:51], s37 offen offset:0 sc1
    v_pk_fma_f32 v[140:141], v[40:41], v[20:21], v[140:141] op_sel_hi:[1,0,1]
    v_pk_fma_f32 v[142:143], v[42:43], v[20:21], v[142:143] op_sel_hi:[1,0,1]
    v_pk_mul_f32 v[64:65], v[140:141], v[20:21] op_sel:[0,1] op_sel_hi:[1,1]
    v_pk_mul_f32 v[66:67], v[142:143], v[20:21] op_sel:[0,1] op_sel_hi:[1,1]
    v_exp_f32 v64, v64
    v_exp_f32 v65, v65
    v_exp_f32 v66, v66
    v_exp_f32 v67, v67
    v_pk_fma_f32 v[204:205], v[56:57], v[20:21], v[204:205] op_sel_hi:[1,0,1]
    v_pk_fma_f32 v[206:207], v[58:59], v[20:21], v[206:207] op_sel_hi:[1,0,1]
    v_pk_fma_f32 v[64:65], v[64:65], v[22:23], v[22:23] op_sel_hi:[1,0,0]
    v_pk_fma_f32 v[66:67], v[66:67], v[22:23], v[22:23] op_sel_hi:[1,0,0]
    v_rcp_f32 v64, v64
    v_rcp_f32 v65, v65
    v_rcp_f32 v66, v66
    v_rcp_f32 v67, v67
    v_pk_mul_f32 v[140:141], v[140:141], v[204:205]
    v_pk_mul_f32 v[142:143], v[142:143], v[206:207]
    v_pk_mul_f32 v[140:141], v[140:141], v[64:65]
    v_pk_mul_f32 v[142:143], v[142:143], v[66:67]
    v_cvt_pk_bf16_f32 v76, v140, v141
    v_cvt_pk_bf16_f32 v77, v142, v143
    v_pk_fma_f32 v[156:157], v[44:45], v[20:21], v[156:157] op_sel_hi:[1,0,1]
    v_pk_fma_f32 v[158:159], v[46:47], v[20:21], v[158:159] op_sel_hi:[1,0,1]
    v_pk_mul_f32 v[64:65], v[156:157], v[20:21] op_sel:[0,1] op_sel_hi:[1,1]
    v_pk_mul_f32 v[66:67], v[158:159], v[20:21] op_sel:[0,1] op_sel_hi:[1,1]
    v_exp_f32 v64, v64
    v_exp_f32 v65, v65
    v_exp_f32 v66, v66
    v_exp_f32 v67, v67
    v_pk_fma_f32 v[220:221], v[60:61], v[20:21], v[220:221] op_sel_hi:[1,0,1]
    v_pk_fma_f32 v[222:223], v[62:63], v[20:21], v[222:223] op_sel_hi:[1,0,1]
    v_pk_fma_f32 v[64:65], v[64:65], v[22:23], v[22:23] op_sel_hi:[1,0,0]
    v_pk_fma_f32 v[66:67], v[66:67], v[22:23], v[22:23] op_sel_hi:[1,0,0]
    v_rcp_f32 v64, v64
    v_rcp_f32 v65, v65
    v_rcp_f32 v66, v66
    v_rcp_f32 v67, v67
    v_pk_mul_f32 v[156:157], v[156:157], v[220:221]
    v_pk_mul_f32 v[158:159], v[158:159], v[222:223]
    v_pk_mul_f32 v[156:157], v[156:157], v[64:65]
    v_pk_mul_f32 v[158:159], v[158:159], v[66:67]
    v_cvt_pk_bf16_f32 v78, v156, v157
    v_cvt_pk_bf16_f32 v79, v158, v159
    buffer_store_dwordx4 v[76:79], v24, s[48:51], s37 offen offset:1024 sc1
L_A2:
    ds_read_b128 v[32:35], v0 offset:32
    s_waitcnt lgkmcnt(0)
LB_35:
    v_xor_b32 v32, s89, v32
    v_xor_b32 v33, s89, v33
    v_xor_b32 v34, s89, v34
    v_xor_b32 v35, s89, v35
    v_or3_b32 v33, v33, v34, v35
    v_or_b32 v32, v32, v33
    v_cmp_ne_u32 vcc, 0, v32
    s_nop 0
    s_cbranch_vccnz LS_34
LO_36:
    ds_read_b128 v[64:67], v26 offset:3584
    ds_read_b128 v[32:35], v25 offset:0
    ds_read_b128 v[36:39], v25 offset:512
    ds_read_b128 v[40:43], v25 offset:1024
    ds_read_b128 v[44:47], v25 offset:1536
    ds_read_b128 v[48:51], v25 offset:2048
    ds_read_b128 v[52:55], v25 offset:2560
    ds_read_b128 v[56:59], v25 offset:3072
    ds_read_b128 v[60:63], v25 offset:3584
    ds_read_b128 v[68:71], v26 offset:3072
    ds_read_b128 v[72:75], v26 offset:2560
    ds_read_b128 v[76:79], v26 offset:2048
    ds_read_b128 v[80:83], v26 offset:1536
    ds_read_b128 v[84:87], v26 offset:1024
    ds_read_b128 v[88:91], v26 offset:512
    ds_read_b128 v[92:95], v26 offset:0
    s_waitcnt lgkmcnt(14)
    v_mfma_f32_16x16x32_bf16 v[160:163], v[32:35], v[64:67], 0
    s_waitcnt lgkmcnt(13)
    v_and_b32 v27, 15, v1
    v_mfma_f32_16x16x32_bf16 v[164:167], v[36:39], v[64:67], 0
    s_waitcnt lgkmcnt(12)
    v_lshrrev_b32 v28, 4, v1
    v_mfma_f32_16x16x32_bf16 v[168:171], v[40:43], v[64:67], 0
    s_waitcnt lgkmcnt(11)
    v_lshl_add_u32 v27, v28, 3, v27
    v_mfma_f32_16x16x32_bf16 v[172:175], v[44:47], v[64:67], 0
    s_waitcnt lgkmcnt(10)
    v_sub_u32 v27, 15, v27
    v_mfma_f32_16x16x32_bf16 v[176:179], v[48:51], v[64:67], 0
    s_waitcnt lgkmcnt(9)
    s_lshl_b32 s92, s81, 4
    v_mfma_f32_16x16x32_bf16 v[180:183], v[52:55], v[64:67], 0
    s_waitcnt lgkmcnt(8)
    s_lshr_b32 s92, s97, s92
    v_mfma_f32_16x16x32_bf16 v[184:187], v[56:59], v[64:67], 0
    s_waitcnt lgkmcnt(7)
    s_and_b32 s92, s92, 0xffff
    v_mfma_f32_16x16x32_bf16 v[188:191], v[60:63], v[64:67], 0
    s_waitcnt lgkmcnt(0)
    v_and_b32 v28, 1, v27
    v_mfma_f32_16x16x32_bf16 v[164:167], v[32:35], v[68:71], v[164:167]
    ds_read_b128 v[128:131], v26 offset:3648
    v_lshlrev_b32 v28, 4, v28
    v_mfma_f32_16x16x32_bf16 v[168:171], v[36:39], v[68:71], v[168:171]
    ds_read_b128 v[96:99], v25 offset:64
    v_lshlrev_b32 v28, v28, s92
    v_mfma_f32_16x16x32_bf16 v[172:175], v[40:43], v[68:71], v[172:175]
    ds_read_b128 v[100:103], v25 offset:576
    v_ashrrev_i32 v27, 1, v27
    v_mfma_f32_16x16x32_bf16 v[176:179], v[44:47], v[68:71], v[176:179]
    ds_read_b128 v[104:107], v25 offset:1088
    v_cmp_eq_u32 vcc, 0, v27
    v_mfma_f32_16x16x32_bf16 v[180:183], v[48:51], v[68:71], v[180:183]
    ds_read_b128 v[108:111], v25 offset:1600
    s_nop 0
    v_mfma_f32_16x16x32_bf16 v[184:187], v[52:55], v[68:71], v[184:187]
    ds_read_b128 v[112:115], v25 offset:2112
    v_cndmask_b32 v192, 0, v28, vcc
    v_mfma_f32_16x16x32_bf16 v[188:191], v[56:59], v[68:71], v[188:191]
    ds_read_b128 v[116:119], v25 offset:2624
    v_cmp_eq_u32 vcc, 1, v27
    v_mfma_f32_16x16x32_bf16 v[168:171], v[32:35], v[72:75], v[168:171]
    ds_read_b128 v[120:123], v25 offset:3136
    s_nop 0
    v_mfma_f32_16x16x32_bf16 v[172:175], v[36:39], v[72:75], v[172:175]
    ds_read_b128 v[124:127], v25 offset:3648
    v_cndmask_b32 v193, 0, v28, vcc
    v_mfma_f32_16x16x32_bf16 v[176:179], v[40:43], v[72:75], v[176:179]
    ds_read_b128 v[132:135], v26 offset:3136
    v_cmp_eq_u32 vcc, 2, v27
    v_mfma_f32_16x16x32_bf16 v[180:183], v[44:47], v[72:75], v[180:183]
    ds_read_b128 v[136:139], v26 offset:2624
    s_nop 0
    v_mfma_f32_16x16x32_bf16 v[184:187], v[48:51], v[72:75], v[184:187]
    ds_read_b128 v[140:143], v26 offset:2112
    v_cndmask_b32 v194, 0, v28, vcc
    v_mfma_f32_16x16x32_bf16 v[188:191], v[52:55], v[72:75], v[188:191]
    ds_read_b128 v[144:147], v26 offset:1600
    v_cmp_eq_u32 vcc, 3, v27
    v_mfma_f32_16x16x32_bf16 v[172:175], v[32:35], v[76:79], v[172:175]
    ds_read_b128 v[148:151], v26 offset:1088
    s_nop 0
    v_mfma_f32_16x16x32_bf16 v[176:179], v[36:39], v[76:79], v[176:179]
    ds_read_b128 v[152:155], v26 offset:576
    v_cndmask_b32 v195, 0, v28, vcc
    s_waitcnt vmcnt(0)
    s_cmp_eq_u32 s3, 0
    s_cbranch_scc1 HP_37
    v_mov_b32 v29, s89
    s_mov_b64 exec, 1
    buffer_store_dword v29, off, s[48:51], s3 sc1
    s_mov_b64 exec, -1
    s_cmp_ge_u32 s2, 40
    s_cbranch_scc1 HP_37
    s_cmp_lg_u32 s80, 0
    s_cbranch_scc1 HP_37
    s_and_b32 s3, s2, 7
    s_lshl_b32 s3, s3, 7
    s_add_u32 s3, s3, 4096
    v_mov_b32 v29, s89
    s_mov_b64 exec, 1
    buffer_store_dword v29, off, s[48:51], s3 sc1
    s_mov_b64 exec, -1
HP_37:
    v_mfma_f32_16x16x32_bf16 v[180:183], v[40:43], v[76:79], v[180:183]
    ds_read_b128 v[156:159], v26 offset:64
    v_mfma_f32_16x16x32_bf16 v[184:187], v[44:47], v[76:79], v[184:187]
    v_mfma_f32_16x16x32_bf16 v[188:191], v[48:51], v[76:79], v[188:191]
    v_mfma_f32_16x16x32_bf16 v[176:179], v[32:35], v[80:83], v[176:179]
    v_mfma_f32_16x16x32_bf16 v[180:183], v[36:39], v[80:83], v[180:183]
    v_mfma_f32_16x16x32_bf16 v[184:187], v[40:43], v[80:83], v[184:187]
    v_mfma_f32_16x16x32_bf16 v[188:191], v[44:47], v[80:83], v[188:191]
    v_mfma_f32_16x16x32_bf16 v[180:183], v[32:35], v[84:87], v[180:183]
    v_mfma_f32_16x16x32_bf16 v[184:187], v[36:39], v[84:87], v[184:187]
    v_mfma_f32_16x16x32_bf16 v[188:191], v[40:43], v[84:87], v[188:191]
    v_mfma_f32_16x16x32_bf16 v[184:187], v[32:35], v[88:91], v[184:187]
    v_mfma_f32_16x16x32_bf16 v[188:191], v[36:39], v[88:91], v[188:191]
    v_mfma_f32_16x16x32_bf16 v[188:191], v[32:35], v[92:95], v[188:191]
    s_cmp_lg_u32 s82, 0
    s_cbranch_scc1 DT_38
    v_mfma_f32_16x16x32_bf16 v[160:163], v[192:195], v[64:67], v[160:163]
    v_mfma_f32_16x16x32_bf16 v[164:167], v[192:195], v[68:71], v[164:167]
    v_mfma_f32_16x16x32_bf16 v[168:171], v[192:195], v[72:75], v[168:171]
    v_mfma_f32_16x16x32_bf16 v[172:175], v[192:195], v[76:79], v[172:175]
    v_mfma_f32_16x16x32_bf16 v[176:179], v[192:195], v[80:83], v[176:179]
    v_mfma_f32_16x16x32_bf16 v[180:183], v[192:195], v[84:87], v[180:183]
    v_mfma_f32_16x16x32_bf16 v[184:187], v[192:195], v[88:91], v[184:187]
    v_mfma_f32_16x16x32_bf16 v[188:191], v[192:195], v[92:95], v[188:191]
DT_38:
    s_waitcnt lgkmcnt(0)
    v_mfma_f32_16x16x32_bf16 v[160:163], v[96:99], v[128:131], v[160:163]
    v_mfma_f32_16x16x32_bf16 v[164:167], v[100:103], v[128:131], v[164:167]
    ds_read_b128 v[64:67], v26 offset:3712
    v_bfe_u32 v17, v1, 1, 3
    v_mfma_f32_16x16x32_bf16 v[168:171], v[104:107], v[128:131], v[168:171]
    ds_read_b128 v[32:35], v25 offset:128
    v_lshlrev_b32 v17, 8, v17
    v_mfma_f32_16x16x32_bf16 v[172:175], v[108:111], v[128:131], v[172:175]
    ds_read_b128 v[36:39], v25 offset:640
    v_and_b32 v16, 1, v1
    v_mfma_f32_16x16x32_bf16 v[176:179], v[112:115], v[128:131], v[176:179]
    ds_read_b128 v[40:43], v25 offset:1152
    v_lshl_or_b32 v17, v16, 2, v17
    v_mfma_f32_16x16x32_bf16 v[180:183], v[116:119], v[128:131], v[180:183]
    ds_read_b128 v[44:47], v25 offset:1664
    v_lshrrev_b32 v2, 4, v1
    v_mfma_f32_16x16x32_bf16 v[184:187], v[120:123], v[128:131], v[184:187]
    ds_read_b128 v[48:51], v25 offset:2176
    v_and_b32 v3, 15, v1
    v_mfma_f32_16x16x32_bf16 v[188:191], v[124:127], v[128:131], v[188:191]
    ds_read_b128 v[52:55], v25 offset:2688
    v_lshlrev_b32 v4, 10, v2
    v_mfma_f32_16x16x32_bf16 v[164:167], v[96:99], v[132:135], v[164:167]
    ds_read_b128 v[56:59], v25 offset:3200
    v_lshl_or_b32 v4, v3, 3, v4
    v_mfma_f32_16x16x32_bf16 v[168:171], v[100:103], v[132:135], v[168:171]
    ds_read_b128 v[60:63], v25 offset:3712
    v_lshl_add_u32 v18, s80, 2, v2
    v_mfma_f32_16x16x32_bf16 v[172:175], v[104:107], v[132:135], v[172:175]
    ds_read_b128 v[68:71], v26 offset:3200
    v_and_b32 v19, 7, v18
    v_mfma_f32_16x16x32_bf16 v[176:179], v[108:111], v[132:135], v[176:179]
    ds_read_b128 v[72:75], v26 offset:2688
    v_xor_b32 v19, v19, v3
    v_mfma_f32_16x16x32_bf16 v[180:183], v[112:115], v[132:135], v[180:183]
    ds_read_b128 v[76:79], v26 offset:2176
    v_lshlrev_b32 v18, 8, v18
    v_mfma_f32_16x16x32_bf16 v[184:187], v[116:119], v[132:135], v[184:187]
    ds_read_b128 v[80:83], v26 offset:1664
    v_lshl_or_b32 v5, v19, 4, v18
    v_mfma_f32_16x16x32_bf16 v[188:191], v[120:123], v[132:135], v[188:191]
    ds_read_b128 v[84:87], v26 offset:1152
    v_lshrrev_b32 v6, 3, v1
    v_mfma_f32_16x16x32_bf16 v[168:171], v[96:99], v[136:139], v[168:171]
    ds_read_b128 v[88:91], v26 offset:640
    v_lshrrev_b32 v19, 5, v1
    v_mfma_f32_16x16x32_bf16 v[172:175], v[100:103], v[136:139], v[172:175]
    ds_read_b128 v[92:95], v26 offset:128
    v_lshl_add_u32 v19, s80, 2, v19
    v_mfma_f32_16x16x32_bf16 v[176:179], v[104:107], v[136:139], v[176:179]
    v_xor_b32 v19, v19, v1
    v_and_b32 v19, 7, v19
    v_mfma_f32_16x16x32_bf16 v[180:183], v[108:111], v[136:139], v[180:183]
    v_lshlrev_b32 v6, 12, v6
    v_lshl_or_b32 v6, v19, 4, v6
    v_mfma_f32_16x16x32_bf16 v[184:187], v[112:115], v[136:139], v[184:187]
    v_xor_b32 v7, 32, v6
    s_lshl_b32 s93, s64, 1
    v_mfma_f32_16x16x32_bf16 v[188:191], v[116:119], v[136:139], v[188:191]
    s_add_u32 s93, s93, s81
    v_and_b32 v18, 7, v3
    v_mfma_f32_16x16x32_bf16 v[172:175], v[96:99], v[140:143], v[172:175]
    v_xor_b32 v18, s93, v18
    v_lshlrev_b32 v18, 4, v18
    v_mfma_f32_16x16x32_bf16 v[176:179], v[100:103], v[140:143], v[176:179]
    v_lshl_or_b32 v18, v3, 9, v18
    v_lshl_or_b32 v18, v2, 1, v18
    v_mfma_f32_16x16x32_bf16 v[180:183], v[104:107], v[140:143], v[180:183]
    s_lshl_b32 s93, s82, 3
    s_add_u32 s93, s93, 114688
    v_mfma_f32_16x16x32_bf16 v[184:187], v[108:111], v[140:143], v[184:187]
    v_add_u32 v12, s93, v18
    v_xor_b32 v13, 32, v12
    v_mfma_f32_16x16x32_bf16 v[188:191], v[112:115], v[140:143], v[188:191]
    v_xor_b32 v14, 64, v12
    v_xor_b32 v15, 0x60, v12
    v_mfma_f32_16x16x32_bf16 v[176:179], v[96:99], v[144:147], v[176:179]
    s_mul_i32 s93, s81, 49152
    s_lshl_b32 s92, s82, 12
    v_mfma_f32_16x16x32_bf16 v[180:183], v[100:103], v[144:147], v[180:183]
    s_add_u32 s93, s93, s92
    s_add_u32 s93, s93, 106496
    v_mfma_f32_16x16x32_bf16 v[184:187], v[104:107], v[144:147], v[184:187]
    v_add_u32 v20, s93, v24
    v_xor_b32 v21, 4096, v20
    v_mfma_f32_16x16x32_bf16 v[188:191], v[108:111], v[144:147], v[188:191]
    v_lshlrev_b32 v22, 5, v3
    v_and_b32 v18, 1, v2
    v_mfma_f32_16x16x32_bf16 v[180:183], v[96:99], v[148:151], v[180:183]
    v_lshl_or_b32 v22, v18, 9, v22
    v_lshrrev_b32 v18, 1, v2
    v_mfma_f32_16x16x32_bf16 v[184:187], v[100:103], v[148:151], v[184:187]
    v_lshl_or_b32 v22, v18, 4, v22
    v_mfma_f32_16x16x32_bf16 v[188:191], v[104:107], v[148:151], v[188:191]
    v_mfma_f32_16x16x32_bf16 v[184:187], v[96:99], v[152:155], v[184:187]
    v_mfma_f32_16x16x32_bf16 v[188:191], v[100:103], v[152:155], v[188:191]
    v_mfma_f32_16x16x32_bf16 v[188:191], v[96:99], v[156:159], v[188:191]
    s_waitcnt lgkmcnt(0)
    v_mfma_f32_16x16x32_bf16 v[160:163], v[32:35], v[64:67], v[160:163]
    v_mfma_f32_16x16x32_bf16 v[164:167], v[36:39], v[64:67], v[164:167]
    ds_read_b128 v[128:131], v26 offset:3776
    v_mfma_f32_16x16x32_bf16 v[168:171], v[40:43], v[64:67], v[168:171]
    ds_read_b128 v[96:99], v25 offset:192
    v_mfma_f32_16x16x32_bf16 v[172:175], v[44:47], v[64:67], v[172:175]
    ds_read_b128 v[100:103], v25 offset:704
    v_mfma_f32_16x16x32_bf16 v[176:179], v[48:51], v[64:67], v[176:179]
    ds_read_b128 v[104:107], v25 offset:1216
    v_mfma_f32_16x16x32_bf16 v[180:183], v[52:55], v[64:67], v[180:183]
    ds_read_b128 v[108:111], v25 offset:1728
    v_mfma_f32_16x16x32_bf16 v[184:187], v[56:59], v[64:67], v[184:187]
    ds_read_b128 v[112:115], v25 offset:2240
    v_mfma_f32_16x16x32_bf16 v[188:191], v[60:63], v[64:67], v[188:191]
    ds_read_b128 v[116:119], v25 offset:2752
    v_mfma_f32_16x16x32_bf16 v[164:167], v[32:35], v[68:71], v[164:167]
    ds_read_b128 v[120:123], v25 offset:3264
    v_mfma_f32_16x16x32_bf16 v[168:171], v[36:39], v[68:71], v[168:171]
    ds_read_b128 v[124:127], v25 offset:3776
    v_mfma_f32_16x16x32_bf16 v[172:175], v[40:43], v[68:71], v[172:175]
    ds_read_b128 v[132:135], v26 offset:3264
    v_mfma_f32_16x16x32_bf16 v[176:179], v[44:47], v[68:71], v[176:179]
    ds_read_b128 v[136:139], v26 offset:2752
    v_mfma_f32_16x16x32_bf16 v[180:183], v[48:51], v[68:71], v[180:183]
    ds_read_b128 v[140:143], v26 offset:2240
    v_mfma_f32_16x16x32_bf16 v[184:187], v[52:55], v[68:71], v[184:187]
    ds_read_b128 v[144:147], v26 offset:1728
    v_mfma_f32_16x16x32_bf16 v[188:191], v[56:59], v[68:71], v[188:191]
    ds_read_b128 v[148:151], v26 offset:1216
    v_mfma_f32_16x16x32_bf16 v[168:171], v[32:35], v[72:75], v[168:171]
    ds_read_b128 v[152:155], v26 offset:704
    v_mfma_f32_16x16x32_bf16 v[172:175], v[36:39], v[72:75], v[172:175]
    ds_read_b128 v[156:159], v26 offset:192
    v_mfma_f32_16x16x32_bf16 v[176:179], v[40:43], v[72:75], v[176:179]
    v_mfma_f32_16x16x32_bf16 v[180:183], v[44:47], v[72:75], v[180:183]
    s_cmp_lt_u32 s2, 32
    s_cbranch_scc1 SIG_39
    v_mov_b32 v29, s89
    v_lshl_add_u32 v30, s80, 2, v0
    ds_write_b32 v30, v29 offset:48
SIG_39:
    v_mfma_f32_16x16x32_bf16 v[184:187], v[48:51], v[72:75], v[184:187]
    v_mfma_f32_16x16x32_bf16 v[188:191], v[52:55], v[72:75], v[188:191]
    v_mfma_f32_16x16x32_bf16 v[172:175], v[32:35], v[76:79], v[172:175]
    v_mfma_f32_16x16x32_bf16 v[176:179], v[36:39], v[76:79], v[176:179]
    v_mfma_f32_16x16x32_bf16 v[180:183], v[40:43], v[76:79], v[180:183]
    v_mfma_f32_16x16x32_bf16 v[184:187], v[44:47], v[76:79], v[184:187]
    v_mfma_f32_16x16x32_bf16 v[188:191], v[48:51], v[76:79], v[188:191]
    v_mfma_f32_16x16x32_bf16 v[176:179], v[32:35], v[80:83], v[176:179]
    v_mfma_f32_16x16x32_bf16 v[180:183], v[36:39], v[80:83], v[180:183]
    v_mfma_f32_16x16x32_bf16 v[184:187], v[40:43], v[80:83], v[184:187]
    v_mfma_f32_16x16x32_bf16 v[188:191], v[44:47], v[80:83], v[188:191]
    v_mfma_f32_16x16x32_bf16 v[180:183], v[32:35], v[84:87], v[180:183]
    v_mfma_f32_16x16x32_bf16 v[184:187], v[36:39], v[84:87], v[184:187]
    v_mfma_f32_16x16x32_bf16 v[188:191], v[40:43], v[84:87], v[188:191]
    v_mfma_f32_16x16x32_bf16 v[184:187], v[32:35], v[88:91], v[184:187]
    v_mfma_f32_16x16x32_bf16 v[188:191], v[36:39], v[88:91], v[188:191]
    v_mfma_f32_16x16x32_bf16 v[188:191], v[32:35], v[92:95], v[188:191]
    s_waitcnt lgkmcnt(0)
    v_mfma_f32_16x16x32_bf16 v[160:163], v[96:99], v[128:131], v[160:163]
    v_mfma_f32_16x16x32_bf16 v[164:167], v[100:103], v[128:131], v[164:167]
    v_mfma_f32_16x16x32_bf16 v[168:171], v[104:107], v[128:131], v[168:171]
    v_lshlrev_b32 v27, 2, v1
    v_mfma_f32_16x16x32_bf16 v[172:175], v[108:111], v[128:131], v[172:175]
    v_mfma_f32_16x16x32_bf16 v[176:179], v[112:115], v[128:131], v[176:179]
    buffer_load_dword v16, v17, s[48:51], s74 offen sc1
    v_mfma_f32_16x16x32_bf16 v[180:183], v[116:119], v[128:131], v[180:183]
    v_mfma_f32_16x16x32_bf16 v[184:187], v[120:123], v[128:131], v[184:187]
    buffer_load_dword v23, v27, s[48:51], s79 offen sc1
    v_mfma_f32_16x16x32_bf16 v[188:191], v[124:127], v[128:131], v[188:191]
    v_mfma_f32_16x16x32_bf16 v[164:167], v[96:99], v[132:135], v[164:167]
    buffer_load_dwordx2 v[212:213], v4, s[32:35], s68 offen
    v_mfma_f32_16x16x32_bf16 v[168:171], v[100:103], v[132:135], v[168:171]
    v_mfma_f32_16x16x32_bf16 v[172:175], v[104:107], v[132:135], v[172:175]
    v_mfma_f32_16x16x32_bf16 v[176:179], v[108:111], v[132:135], v[176:179]
    v_mfma_f32_16x16x32_bf16 v[180:183], v[112:115], v[132:135], v[180:183]
    buffer_load_dwordx2 v[214:215], v4, s[32:35], s69 offen
    v_mfma_f32_16x16x32_bf16 v[184:187], v[116:119], v[132:135], v[184:187]
    v_mfma_f32_16x16x32_bf16 v[188:191], v[120:123], v[132:135], v[188:191]
    v_mfma_f32_16x16x32_bf16 v[168:171], v[96:99], v[136:139], v[168:171]
    v_mfma_f32_16x16x32_bf16 v[172:175], v[100:103], v[136:139], v[172:175]
    buffer_load_dwordx2 v[216:217], v4, s[32:35], s70 offen
    v_mfma_f32_16x16x32_bf16 v[176:179], v[104:107], v[136:139], v[176:179]
    v_mfma_f32_16x16x32_bf16 v[180:183], v[108:111], v[136:139], v[180:183]
    v_mfma_f32_16x16x32_bf16 v[184:187], v[112:115], v[136:139], v[184:187]
    v_mfma_f32_16x16x32_bf16 v[188:191], v[116:119], v[136:139], v[188:191]
    buffer_load_dwordx2 v[218:219], v4, s[32:35], s71 offen
    v_mfma_f32_16x16x32_bf16 v[172:175], v[96:99], v[140:143], v[172:175]
    v_mfma_f32_16x16x32_bf16 v[176:179], v[100:103], v[140:143], v[176:179]
    v_mfma_f32_16x16x32_bf16 v[180:183], v[104:107], v[140:143], v[180:183]
    v_mfma_f32_16x16x32_bf16 v[184:187], v[108:111], v[140:143], v[184:187]
    v_mfma_f32_16x16x32_bf16 v[188:191], v[112:115], v[140:143], v[188:191]
    v_mfma_f32_16x16x32_bf16 v[176:179], v[96:99], v[144:147], v[176:179]
    v_mfma_f32_16x16x32_bf16 v[180:183], v[100:103], v[144:147], v[180:183]
    v_mfma_f32_16x16x32_bf16 v[184:187], v[104:107], v[144:147], v[184:187]
    v_mfma_f32_16x16x32_bf16 v[188:191], v[108:111], v[144:147], v[188:191]
    v_mfma_f32_16x16x32_bf16 v[180:183], v[96:99], v[148:151], v[180:183]
    v_mfma_f32_16x16x32_bf16 v[184:187], v[100:103], v[148:151], v[184:187]
    v_mfma_f32_16x16x32_bf16 v[188:191], v[104:107], v[148:151], v[188:191]
    v_mfma_f32_16x16x32_bf16 v[184:187], v[96:99], v[152:155], v[184:187]
    v_mfma_f32_16x16x32_bf16 v[188:191], v[100:103], v[152:155], v[188:191]
    v_mfma_f32_16x16x32_bf16 v[188:191], v[96:99], v[156:159], v[188:191]
    s_setprio 0
    s_nop 5
    s_cmp_eq_u32 s82, 0
    s_cbranch_scc1 CX_40
    v_swap_b32 v160, v176
    v_swap_b32 v161, v177
    v_swap_b32 v162, v178
    v_swap_b32 v163, v179
    v_swap_b32 v164, v180
    v_swap_b32 v165, v181
    v_swap_b32 v166, v182
    v_swap_b32 v167, v183
    v_swap_b32 v168, v184
    v_swap_b32 v169, v185
    v_swap_b32 v170, v186
    v_swap_b32 v171, v187
    v_swap_b32 v172, v188
    v_swap_b32 v173, v189
    v_swap_b32 v174, v190
    v_swap_b32 v175, v191
CX_40:
    ds_write_b128 v20, v[176:179] offset:0
    ds_write_b128 v20, v[180:183] offset:1024
    ds_write_b128 v20, v[184:187] offset:2048
    ds_write_b128 v20, v[188:191] offset:3072
    s_waitcnt lgkmcnt(0)
    v_mov_b32 v28, s89
    v_lshl_add_u32 v29, s80, 2, v0
    ds_write_b32 v29, v28 offset:64
    ds_read_b128 v[32:35], v0 offset:64
    s_waitcnt lgkmcnt(0)
LB_42:
    v_xor_b32 v32, s89, v32
    v_xor_b32 v33, s89, v33
    v_xor_b32 v34, s89, v34
    v_xor_b32 v35, s89, v35
    v_or3_b32 v33, v33, v34, v35
    v_or_b32 v32, v32, v33
    v_cmp_ne_u32 vcc, 0, v32
    s_nop 0
    s_cbranch_vccnz LS_41
LO_43:
    ds_read_b128 v[176:179], v21 offset:0
    ds_read_b128 v[180:183], v21 offset:1024
    ds_read_b128 v[184:187], v21 offset:2048
    ds_read_b128 v[188:191], v21 offset:3072
    s_waitcnt lgkmcnt(2)
    v_add_f32 v160, v160, v176
    v_add_f32 v161, v161, v177
    v_add_f32 v162, v162, v178
    v_add_f32 v163, v163, v179
    v_add_f32 v164, v164, v180
    v_add_f32 v165, v165, v181
    v_add_f32 v166, v166, v182
    v_add_f32 v167, v167, v183
    v_cvt_pk_bf16_f32 v32, v160, v161
    v_cvt_pk_bf16_f32 v33, v162, v163
    v_cvt_pk_bf16_f32 v34, v164, v165
    v_cvt_pk_bf16_f32 v35, v166, v167
    s_nop 1
    v_permlane16_swap_b32 v32, v34
    v_permlane16_swap_b32 v33, v35
    buffer_store_dwordx4 v[32:35], v22, s[48:51], s77 offen offset:0 sc1
    s_waitcnt lgkmcnt(0)
    v_add_f32 v168, v168, v184
    v_add_f32 v169, v169, v185
    v_add_f32 v170, v170, v186
    v_add_f32 v171, v171, v187
    v_add_f32 v172, v172, v188
    v_add_f32 v173, v173, v189
    v_add_f32 v174, v174, v190
    v_add_f32 v175, v175, v191
    v_cvt_pk_bf16_f32 v36, v168, v169
    v_cvt_pk_bf16_f32 v37, v170, v171
    v_cvt_pk_bf16_f32 v38, v172, v173
    v_cvt_pk_bf16_f32 v39, v174, v175
    s_nop 1
    v_permlane16_swap_b32 v36, v38
    v_permlane16_swap_b32 v37, v39
    buffer_store_dwordx4 v[36:39], v22, s[48:51], s77 offen offset:1024 sc1
    s_cmp_ge_u32 s2, 32
    s_cbranch_scc1 PH_44
    s_and_b32 s92, s2, 7
    s_lshl_b32 s92, s92, 7
    s_add_u32 s92, s92, 4096
    buffer_load_dword v28, off, s[48:51], s92 sc1
    s_waitcnt vmcnt(0)
    s_waitcnt vmcnt(0)
BACK_46:
    v_cmp_ne_u32 vcc, s89, v28
    s_nop 0
    s_cbranch_vccnz SLOW_45
OK_47:
    s_sleep 8
    v_mov_b32 v29, s89
    v_lshl_add_u32 v30, s80, 2, v0
    ds_write_b32 v30, v29 offset:48
    buffer_load_dword v16, v17, s[48:51], s74 offen sc1
    buffer_load_dword v23, v27, s[48:51], s79 offen sc1
    s_waitcnt vmcnt(0)
PH_44:
    s_waitcnt vmcnt(6)
BACK_49:
    v_xor_b32 v16, s89, v16
    v_xor_b32 v23, s89, v23
    v_or_b32 v16, v16, v23
    v_cmp_ne_u32 vcc, 0, v16
    s_nop 0
    s_cbranch_vccnz SLOW_48
OK_50:
    v_lshlrev_b32 v17, 4, v2
    s_lshl_b32 s92, s64, 8
    s_add_u32 s92, s92, s73
    buffer_load_dwordx4 v[196:199], v17, s[48:51], s92 offen sc1
    s_lshl_b32 s92, s65, 8
    s_add_u32 s92, s92, s73
    buffer_load_dwordx4 v[200:203], v17, s[48:51], s92 offen sc1
    s_lshl_b32 s92, s66, 8
    s_add_u32 s92, s92, s73
    buffer_load_dwordx4 v[204:207], v17, s[48:51], s92 offen sc1
    s_lshl_b32 s92, s67, 8
    s_add_u32 s92, s92, s73
    buffer_load_dwordx4 v[208:211], v17, s[48:51], s92 offen sc1
    s_add_u32 m0, s36, 114688
    s_add_u32 s92, s36, 114688
    v_add_u32 v16, s92, v24
    s_waitcnt vmcnt(0)
    v_lshlrev_b32 v64, 16, v212
    v_and_b32 v65, 0xffff0000, v212
    v_lshlrev_b32 v66, 16, v213
    v_and_b32 v67, 0xffff0000, v213
    v_add_f32 v64, v64, v196
    v_add_f32 v65, v65, v196
    v_add_f32 v66, v66, v196
    v_add_f32 v67, v67, v196
    v_mul_f32 v64, v64, v199
    v_mul_f32 v65, v65, v199
    v_mul_f32 v66, v66, v199
    v_mul_f32 v67, v67, v199
    v_lshlrev_b32 v68, 16, v214
    v_and_b32 v69, 0xffff0000, v214
    v_lshlrev_b32 v70, 16, v215
    v_and_b32 v71, 0xffff0000, v215
    v_add_f32 v68, v68, v200
    v_add_f32 v69, v69, v200
    v_add_f32 v70, v70, v200
    v_add_f32 v71, v71, v200
    v_mul_f32 v68, v68, v203
    v_mul_f32 v69, v69, v203
    v_mul_f32 v70, v70, v203
    v_mul_f32 v71, v71, v203
    v_lshlrev_b32 v72, 16, v216
    v_and_b32 v73, 0xffff0000, v216
    v_lshlrev_b32 v74, 16, v217
    v_and_b32 v75, 0xffff0000, v217
    v_add_f32 v72, v72, v204
    v_add_f32 v73, v73, v204
    v_add_f32 v74, v74, v204
    v_add_f32 v75, v75, v204
    v_mul_f32 v72, v72, v207
    v_mul_f32 v73, v73, v207
    v_mul_f32 v74, v74, v207
    v_mul_f32 v75, v75, v207
    v_lshlrev_b32 v76, 16, v218
    v_and_b32 v77, 0xffff0000, v218
    v_lshlrev_b32 v78, 16, v219
    v_and_b32 v79, 0xffff0000, v219
    v_add_f32 v76, v76, v208
    v_add_f32 v77, v77, v208
    v_add_f32 v78, v78, v208
    v_add_f32 v79, v79, v208
    v_mul_f32 v76, v76, v211
    v_mul_f32 v77, v77, v211
    v_mul_f32 v78, v78, v211
    v_mul_f32 v79, v79, v211
    v_mov_b32 v96, 0
    v_mov_b32 v97, 0
    v_mov_b32 v98, 0
    v_mov_b32 v99, 0
    v_mov_b32 v100, 0
    v_mov_b32 v101, 0
    v_mov_b32 v102, 0
    v_mov_b32 v103, 0
    v_mov_b32 v104, 0
    v_mov_b32 v105, 0
    v_mov_b32 v106, 0
    v_mov_b32 v107, 0
    v_mov_b32 v108, 0
    v_mov_b32 v109, 0
    v_mov_b32 v110, 0
    v_mov_b32 v111, 0
    s_barrier
    buffer_load_dwordx4 v6, s[48:51], s75 offen sc1 lds
    buffer_load_dwordx4 v7, s[48:51], s76 offen offset:1024 sc1 lds
    ds_read_b128 v[40:43], v5 offset:0
    ds_read_b128 v[44:47], v5 offset:4096
    ds_read_b128 v[48:51], v5 offset:8192
    ds_read_b128 v[52:55], v5 offset:12288
    s_waitcnt lgkmcnt(2)
    v_add_f32 v40, v40, v44
    v_add_f32 v41, v41, v45
    v_add_f32 v42, v42, v46
    v_add_f32 v43, v43, v47
    s_waitcnt lgkmcnt(0)
    v_add_f32 v48, v48, v52
    v_add_f32 v49, v49, v53
    v_add_f32 v50, v50, v54
    v_add_f32 v51, v51, v55
    v_add_f32 v40, v40, v48
    v_add_f32 v41, v41, v49
    v_add_f32 v42, v42, v50
    v_add_f32 v43, v43, v51
    v_mul_f32 v44, s101, v40
    v_mul_f32 v45, s101, v41
    v_mul_f32 v46, s101, v42
    v_mul_f32 v47, s101, v43
    v_exp_f32 v44, v44
    v_exp_f32 v45, v45
    v_exp_f32 v46, v46
    v_exp_f32 v47, v47
    v_mul_f32 v64, v64, v40
    v_mul_f32 v65, v65, v41
    v_mul_f32 v66, v66, v42
    v_mul_f32 v67, v67, v43
    v_add_f32 v44, 1.0, v44
    v_add_f32 v45, 1.0, v45
    v_add_f32 v46, 1.0, v46
    v_add_f32 v47, 1.0, v47
    v_rcp_f32 v44, v44
    v_rcp_f32 v45, v45
    v_rcp_f32 v46, v46
    v_rcp_f32 v47, v47
    s_nop 0
    v_mul_f32 v64, v64, v44
    v_mul_f32 v65, v65, v45
    v_mul_f32 v66, v66, v46
    v_mul_f32 v67, v67, v47
    s_waitcnt vmcnt(0)
YB_51:
    ds_read_b128 v[88:91], v16
    ds_read_b128 v[92:95], v16 offset:1024
    s_waitcnt lgkmcnt(0)
    v_pk_max_u16 v88, v88, v89
    v_pk_max_u16 v90, v90, v91
    v_pk_max_u16 v92, v92, v93
    v_pk_max_u16 v94, v94, v95
    v_pk_max_u16 v88, v88, v90
    v_pk_max_u16 v92, v92, v94
    v_pk_max_u16 v88, v88, v92
    v_lshrrev_b32 v89, 16, v88
    v_max_u16 v88, v88, v89
    v_cmp_eq_u16 vcc, -1, v88
    s_nop 0
    s_cbranch_vccnz YS_52
YO_53:
    s_barrier
    ds_read_u16_d16_hi v96, v12 offset:0
    ds_read_u16_d16_hi v97, v12 offset:128
    ds_read_u16_d16_hi v98, v12 offset:256
    ds_read_u16_d16_hi v99, v12 offset:384
    ds_read_u16_d16_hi v100, v13 offset:0
    ds_read_u16_d16_hi v101, v13 offset:128
    ds_read_u16_d16_hi v102, v13 offset:256
    ds_read_u16_d16_hi v103, v13 offset:384
    ds_read_u16_d16_hi v104, v14 offset:0
    ds_read_u16_d16_hi v105, v14 offset:128
    ds_read_u16_d16_hi v106, v14 offset:256
    ds_read_u16_d16_hi v107, v14 offset:384
    ds_read_u16_d16_hi v108, v15 offset:0
    ds_read_u16_d16_hi v109, v15 offset:128
    ds_read_u16_d16_hi v110, v15 offset:256
    ds_read_u16_d16_hi v111, v15 offset:384
    ds_read_b128 v[40:43], v5 offset:16384
    ds_read_b128 v[44:47], v5 offset:20480
    ds_read_b128 v[48:51], v5 offset:24576
    ds_read_b128 v[52:55], v5 offset:28672
    s_waitcnt lgkmcnt(2)
    v_add_f32 v40, v40, v44
    v_add_f32 v41, v41, v45
    v_add_f32 v42, v42, v46
    v_add_f32 v43, v43, v47
    s_waitcnt lgkmcnt(0)
    v_add_f32 v48, v48, v52
    v_add_f32 v49, v49, v53
    v_add_f32 v50, v50, v54
    v_add_f32 v51, v51, v55
    v_add_f32 v40, v40, v48
    v_add_f32 v41, v41, v49
    v_add_f32 v42, v42, v50
    v_add_f32 v43, v43, v51
    v_mul_f32 v44, s101, v40
    v_mul_f32 v45, s101, v41
    v_mul_f32 v46, s101, v42
    v_mul_f32 v47, s101, v43
    v_exp_f32 v44, v44
    v_exp_f32 v45, v45
    v_exp_f32 v46, v46
    v_exp_f32 v47, v47
    v_mul_f32 v68, v68, v40
    v_mul_f32 v69, v69, v41
    v_mul_f32 v70, v70, v42
    v_mul_f32 v71, v71, v43
    v_add_f32 v44, 1.0, v44
    v_add_f32 v45, 1.0, v45
    v_add_f32 v46, 1.0, v46
    v_add_f32 v47, 1.0, v47
    v_rcp_f32 v44, v44
    v_rcp_f32 v45, v45
    v_rcp_f32 v46, v46
    v_rcp_f32 v47, v47
    s_nop 0
    v_mul_f32 v68, v68, v44
    v_mul_f32 v69, v69, v45
    v_mul_f32 v70, v70, v46
    v_mul_f32 v71, v71, v47
    v_mul_f32 v76, v76, v108
    v_mul_f32 v77, v77, v109
    v_mul_f32 v78, v78, v110
    v_mul_f32 v79, v79, v111
    v_lshlrev_b32 v92, 16, v212
    v_and_b32 v93, 0xffff0000, v212
    v_lshlrev_b32 v94, 16, v213
    v_and_b32 v95, 0xffff0000, v213
    v_fma_f32 v88, v96, v64, v92
    v_fma_f32 v89, v97, v65, v93
    v_fma_f32 v90, v98, v66, v94
    v_fma_f32 v91, v99, v67, v95
    v_cvt_pk_bf16_f32 v64, v88, v89
    v_cvt_pk_bf16_f32 v65, v90, v91
    buffer_store_dwordx2 v[64:65], v4, s[56:59], s68 offen
    v_lshlrev_b32 v92, 16, v214
    v_and_b32 v93, 0xffff0000, v214
    v_lshlrev_b32 v94, 16, v215
    v_and_b32 v95, 0xffff0000, v215
    v_fma_f32 v88, v100, v68, v92
    v_fma_f32 v89, v101, v69, v93
    v_fma_f32 v90, v102, v70, v94
    v_fma_f32 v91, v103, v71, v95
    v_cvt_pk_bf16_f32 v68, v88, v89
    v_cvt_pk_bf16_f32 v69, v90, v91
    buffer_store_dwordx2 v[68:69], v4, s[56:59], s69 offen
    s_barrier
    ds_read_b128 v[40:43], v5 offset:0
    ds_read_b128 v[44:47], v5 offset:4096
    ds_read_b128 v[48:51], v5 offset:8192
    ds_read_b128 v[52:55], v5 offset:12288
    s_waitcnt lgkmcnt(2)
    v_add_f32 v40, v40, v44
    v_add_f32 v41, v41, v45
    v_add_f32 v42, v42, v46
    v_add_f32 v43, v43, v47
    s_waitcnt lgkmcnt(0)
    v_add_f32 v48, v48, v52
    v_add_f32 v49, v49, v53
    v_add_f32 v50, v50, v54
    v_add_f32 v51, v51, v55
    v_add_f32 v40, v40, v48
    v_add_f32 v41, v41, v49
    v_add_f32 v42, v42, v50
    v_add_f32 v43, v43, v51
    v_mul_f32 v44, s101, v40
    v_mul_f32 v45, s101, v41
    v_mul_f32 v46, s101, v42
    v_mul_f32 v47, s101, v43
    v_exp_f32 v44, v44
    v_exp_f32 v45, v45
    v_exp_f32 v46, v46
    v_exp_f32 v47, v47
    v_mul_f32 v72, v72, v40
    v_mul_f32 v73, v73, v41
    v_mul_f32 v74, v74, v42
    v_mul_f32 v75, v75, v43
    v_add_f32 v44, 1.0, v44
    v_add_f32 v45, 1.0, v45
    v_add_f32 v46, 1.0, v46
    v_add_f32 v47, 1.0, v47
    v_rcp_f32 v44, v44
    v_rcp_f32 v45, v45
    v_rcp_f32 v46, v46
    v_rcp_f32 v47, v47
    s_nop 0
    v_mul_f32 v72, v72, v44
    v_mul_f32 v73, v73, v45
    v_mul_f32 v74, v74, v46
    v_mul_f32 v75, v75, v47
    v_lshlrev_b32 v92, 16, v216
    v_and_b32 v93, 0xffff0000, v216
    v_lshlrev_b32 v94, 16, v217
    v_and_b32 v95, 0xffff0000, v217
    v_fma_f32 v88, v104, v72, v92
    v_fma_f32 v89, v105, v73, v93
    v_fma_f32 v90, v106, v74, v94
    v_fma_f32 v91, v107, v75, v95
    v_cvt_pk_bf16_f32 v72, v88, v89
    v_cvt_pk_bf16_f32 v73, v90, v91
    buffer_store_dwordx2 v[72:73], v4, s[56:59], s70 offen
    v_lshlrev_b32 v92, 16, v218
    v_and_b32 v93, 0xffff0000, v218
    v_lshlrev_b32 v94, 16, v219
    v_and_b32 v95, 0xffff0000, v219
    s_barrier
    ds_read_b128 v[40:43], v5 offset:16384
    ds_read_b128 v[44:47], v5 offset:20480
    ds_read_b128 v[48:51], v5 offset:24576
    ds_read_b128 v[52:55], v5 offset:28672
    v_mov_b32 v88, s101
    s_waitcnt lgkmcnt(2)
    v_pk_add_f32 v[40:41], v[40:41], v[44:45]
    v_pk_add_f32 v[42:43], v[42:43], v[46:47]
    s_waitcnt lgkmcnt(0)
    v_pk_add_f32 v[48:49], v[48:49], v[52:53]
    v_pk_add_f32 v[50:51], v[50:51], v[54:55]
    v_pk_add_f32 v[40:41], v[40:41], v[48:49]
    v_pk_add_f32 v[42:43], v[42:43], v[50:51]
    v_pk_mul_f32 v[44:45], v[40:41], v[88:89] op_sel_hi:[1,0]
    v_pk_mul_f32 v[46:47], v[42:43], v[88:89] op_sel_hi:[1,0]
    v_exp_f32 v44, v44
    v_exp_f32 v45, v45
    v_exp_f32 v46, v46
    v_exp_f32 v47, v47
    v_pk_mul_f32 v[40:41], v[40:41], v[76:77]
    v_pk_mul_f32 v[42:43], v[42:43], v[78:79]
    v_pk_add_f32 v[44:45], v[44:45], 1.0 op_sel_hi:[1,0]
    v_pk_add_f32 v[46:47], v[46:47], 1.0 op_sel_hi:[1,0]
    v_rcp_f32 v44, v44
    v_rcp_f32 v45, v45
    v_rcp_f32 v46, v46
    v_rcp_f32 v47, v47
    s_nop 0
    v_pk_fma_f32 v[88:89], v[40:41], v[44:45], v[92:93]
    v_pk_fma_f32 v[90:91], v[42:43], v[46:47], v[94:95]
    v_cvt_pk_bf16_f32 v88, v88, v89
    v_cvt_pk_bf16_f32 v89, v90, v91
    buffer_store_dwordx2 v[88:89], v4, s[56:59], s71 offen
    s_endpgm
L_END:
    s_endpgm
L_HELPER:
    s_lshl_b32 s84, s2, 3
    s_add_u32 s84, s84, s100
    v_lshlrev_b32 v30, 4, v1
    v_lshrrev_b32 v2, 3, v1
    v_and_b32 v4, 7, v1
    v_lshlrev_b32 v4, 4, v4
    s_lshl_b32 s85, s100, 13
    s_waitcnt lgkmcnt(0)
    s_lshr_b32 s92, s2, 3
    s_lshl_b32 s92, s92, 3
    s_add_u32 s72, s92, s100
    s_and_b32 s73, s2, 7
    s_mov_b32 s64, s6
    s_and_b32 s65, s7, 0xffff
    s_mov_b32 s66, 2097152
    s_mov_b32 s67, 0x00020000
    s_mov_b32 s68, s8
    s_and_b32 s69, s9, 0xffff
    s_mov_b32 s70, 2097152
    s_mov_b32 s71, 0x00020000
    s_mov_b32 s36, s10
    s_and_b32 s37, s11, 0xffff
    s_mov_b32 s38, 4096
    s_mov_b32 s39, 0x00020000
    s_and_b32 s92, s84, 7
    s_lshl_b32 s94, s92, 9
    s_lshl_b32 s92, s92, 7
    s_lshr_b32 s93, s84, 3
    s_lshl_b32 s93, s93, 16
    s_add_u32 s92, s92, s93
    v_lshl_or_b32 v6, v2, 13, v4
    v_add_u32 v6, s92, v6
    v_subrev_u32 v7, 3072, v6
    v_lshlrev_b32 v9, 2, v4
    s_mov_b32 s60, s26
    s_and_b32 s61, s27, 0xffff
    s_mov_b32 s62, 256
    s_mov_b32 s63, 0x00020000
    s_cmp_lg_u32 s84, 0
    s_cbranch_scc1 NON_54
    s_memrealtime s[86:87]
    s_waitcnt lgkmcnt(0)
    s_or_b32 s86, s86, 1
    v_mov_b32 v8, s86
    s_mov_b64 exec, 1
    buffer_store_dword v8, off, s[60:63], 0 sc1
    s_mov_b64 exec, -1
NON_54:
    buffer_load_dwordx4 v[172:175], v9, s[36:39], s94 offen offset:0
    buffer_load_dwordx4 v[176:179], v9, s[36:39], s94 offen offset:16
    buffer_load_dwordx4 v[180:183], v9, s[36:39], s94 offen offset:32
    buffer_load_dwordx4 v[184:187], v9, s[36:39], s94 offen offset:48
    buffer_load_dwordx4 v[64:67], v7, s[64:67], 0 offen offset:0 nt
    buffer_load_dwordx4 v[68:71], v7, s[64:67], 0 offen offset:1024 nt
    buffer_load_dwordx4 v[72:75], v7, s[64:67], 0 offen offset:2048 nt
    s_mov_b32 s87, 0
    s_and_b32 s92, s2, 7
    s_lshr_b32 s93, s2, 3
    s_and_b32 s91, s93, 7
    s_lshr_b32 s93, s93, 3
    s_lshl_b32 s90, s92, 2
    s_add_u32 s90, s90, s93
    s_lshl_b32 s30, s2, 1
    s_add_u32 s30, s30, s81
    s_mov_b32 s48, s28
    s_and_b32 s49, s29, 0xffff
    s_mov_b32 s50, 268435456
    s_mov_b32 s51, 0x00020000
    s_mov_b32 s60, s26
    s_and_b32 s61, s27, 0xffff
    s_mov_b32 s62, 256
    s_mov_b32 s63, 0x00020000
    s_lshl_b32 s92, s2, 2
    s_load_dword s97, s[14:15], s92
    v_and_b32 v9, 7, v1
    v_sub_u32 v10, 7, v2
    v_xor_b32 v10, v10, v9
    v_lshlrev_b32 v11, 10, v9
    v_lshl_or_b32 v10, v10, 4, v11
    v_add_u32 v10, s85, v10
    v_lshlrev_b32 v11, 7, v2
    v_lshl_or_b32 v11, v9, 4, v11
    v_add_u32 v11, s85, v11
    v_lshl_or_b32 v12, v2, 12, v4
    s_and_b32 s92, s84, 7
    s_lshl_b32 s92, s92, 18
    s_lshr_b32 s93, s84, 3
    s_sub_u32 s93, 31, s93
    s_lshl_b32 s93, s93, 7
    s_add_u32 s92, s92, s93
    s_add_u32 s73, s92, 1048576
    s_and_b32 s92, s84, 7
    s_lshl_b32 s92, s92, 7
    s_lshr_b32 s93, s84, 3
    s_lshl_b32 s93, s93, 2
    s_add_u32 s92, s92, s93
    s_add_u32 s75, s92, 0
    s_waitcnt lgkmcnt(0)
    s_waitcnt vmcnt(3)
    v_lshlrev_b32 v140, 16, v172
    v_and_b32 v148, 0xffff0000, v172
    v_lshlrev_b32 v156, 16, v173
    v_and_b32 v164, 0xffff0000, v173
    v_lshlrev_b32 v141, 16, v174
    v_and_b32 v149, 0xffff0000, v174
    v_lshlrev_b32 v157, 16, v175
    v_and_b32 v165, 0xffff0000, v175
    s_mov_b32 s87, 0
    buffer_load_dwordx4 v[76:79], v6, s[64:67], s87 offen offset:0 nt
    v_lshlrev_b32 v142, 16, v176
    v_and_b32 v150, 0xffff0000, v176
    v_lshlrev_b32 v158, 16, v177
    v_and_b32 v166, 0xffff0000, v177
    v_lshlrev_b32 v143, 16, v178
    v_and_b32 v151, 0xffff0000, v178
    v_lshlrev_b32 v159, 16, v179
    v_and_b32 v167, 0xffff0000, v179
    buffer_load_dwordx4 v[80:83], v6, s[68:71], s87 offen offset:0 nt
    v_lshlrev_b32 v144, 16, v180
    v_and_b32 v152, 0xffff0000, v180
    v_lshlrev_b32 v160, 16, v181
    v_and_b32 v168, 0xffff0000, v181
    v_lshlrev_b32 v145, 16, v182
    v_and_b32 v153, 0xffff0000, v182
    v_lshlrev_b32 v161, 16, v183
    v_and_b32 v169, 0xffff0000, v183
    buffer_load_dwordx4 v[84:87], v6, s[64:67], s87 offen offset:1024 nt
    v_lshlrev_b32 v146, 16, v184
    v_and_b32 v154, 0xffff0000, v184
    v_lshlrev_b32 v162, 16, v185
    v_and_b32 v170, 0xffff0000, v185
    v_lshlrev_b32 v147, 16, v186
    v_and_b32 v155, 0xffff0000, v186
    v_lshlrev_b32 v163, 16, v187
    v_and_b32 v171, 0xffff0000, v187
    buffer_load_dwordx4 v[88:91], v6, s[68:71], s87 offen offset:1024 nt
    s_waitcnt vmcnt(6)
    v_lshlrev_b32 v180, 16, v64
    v_and_b32 v181, 0xffff0000, v64
    v_lshlrev_b32 v182, 16, v65
    v_and_b32 v183, 0xffff0000, v65
    v_lshlrev_b32 v184, 16, v66
    v_and_b32 v185, 0xffff0000, v66
    v_lshlrev_b32 v186, 16, v67
    v_and_b32 v187, 0xffff0000, v67
    buffer_load_dwordx4 v[92:95], v6, s[64:67], s87 offen offset:2048 nt
    s_waitcnt vmcnt(6)
    v_lshlrev_b32 v188, 16, v68
    v_and_b32 v189, 0xffff0000, v68
    v_lshlrev_b32 v190, 16, v69
    v_and_b32 v191, 0xffff0000, v69
    v_lshlrev_b32 v192, 16, v70
    v_and_b32 v193, 0xffff0000, v70
    v_lshlrev_b32 v194, 16, v71
    v_and_b32 v195, 0xffff0000, v71
    buffer_load_dwordx4 v[96:99], v6, s[68:71], s87 offen offset:2048 nt
    s_waitcnt vmcnt(6)
    v_lshlrev_b32 v196, 16, v72
    v_and_b32 v197, 0xffff0000, v72
    v_lshlrev_b32 v198, 16, v73
    v_and_b32 v199, 0xffff0000, v73
    v_lshlrev_b32 v200, 16, v74
    v_and_b32 v201, 0xffff0000, v74
    v_lshlrev_b32 v202, 16, v75
    v_and_b32 v203, 0xffff0000, v75
    buffer_load_dwordx4 v[100:103], v6, s[64:67], s87 offen offset:3072 nt
    s_waitcnt vmcnt(6)
    v_lshlrev_b32 v172, 16, v76
    v_and_b32 v173, 0xffff0000, v76
    v_lshlrev_b32 v174, 16, v77
    v_and_b32 v175, 0xffff0000, v77
    v_lshlrev_b32 v176, 16, v78
    v_and_b32 v177, 0xffff0000, v78
    v_lshlrev_b32 v178, 16, v79
    v_and_b32 v179, 0xffff0000, v79
    buffer_load_dwordx4 v[104:107], v6, s[68:71], s87 offen offset:3072 nt
    s_waitcnt vmcnt(6)
    v_pk_mul_f32 v[204:205], v[180:181], v[164:165]
    v_pk_mul_f32 v[206:207], v[182:183], v[166:167]
    v_pk_mul_f32 v[208:209], v[184:185], v[168:169]
    v_pk_mul_f32 v[210:211], v[186:187], v[170:171]
    v_pk_fma_f32 v[204:205], v[188:189], v[156:157], v[204:205]
    v_pk_fma_f32 v[206:207], v[190:191], v[158:159], v[206:207]
    v_pk_fma_f32 v[208:209], v[192:193], v[160:161], v[208:209]
    v_pk_fma_f32 v[210:211], v[194:195], v[162:163], v[210:211]
    v_pk_fma_f32 v[204:205], v[196:197], v[148:149], v[204:205]
    v_pk_fma_f32 v[206:207], v[198:199], v[150:151], v[206:207]
    v_pk_fma_f32 v[208:209], v[200:201], v[152:153], v[208:209]
    v_pk_fma_f32 v[210:211], v[202:203], v[154:155], v[210:211]
    v_pk_fma_f32 v[204:205], v[172:173], v[140:141], v[204:205]
    v_pk_fma_f32 v[206:207], v[174:175], v[142:143], v[206:207]
    v_pk_fma_f32 v[208:209], v[176:177], v[144:145], v[208:209]
    v_pk_fma_f32 v[210:211], v[178:179], v[146:147], v[210:211]
    v_lshlrev_b32 v24, 16, v80
    v_and_b32 v25, 0xffff0000, v80
    v_pk_mul_f32 v[204:205], v[204:205], v[24:25]
    v_lshlrev_b32 v24, 16, v81
    v_and_b32 v25, 0xffff0000, v81
    v_pk_mul_f32 v[206:207], v[206:207], v[24:25]
    v_lshlrev_b32 v24, 16, v82
    v_and_b32 v25, 0xffff0000, v82
    v_pk_mul_f32 v[208:209], v[208:209], v[24:25]
    v_lshlrev_b32 v24, 16, v83
    v_and_b32 v25, 0xffff0000, v83
    v_pk_mul_f32 v[210:211], v[210:211], v[24:25]
    s_mov_b32 s87, 4096
    buffer_load_dwordx4 v[108:111], v6, s[64:67], s87 offen offset:0 nt
    s_waitcnt vmcnt(6)
    v_lshlrev_b32 v180, 16, v84
    v_and_b32 v181, 0xffff0000, v84
    v_lshlrev_b32 v182, 16, v85
    v_and_b32 v183, 0xffff0000, v85
    v_lshlrev_b32 v184, 16, v86
    v_and_b32 v185, 0xffff0000, v86
    v_lshlrev_b32 v186, 16, v87
    v_and_b32 v187, 0xffff0000, v87
    buffer_load_dwordx4 v[112:115], v6, s[68:71], s87 offen offset:0 nt
    s_waitcnt vmcnt(6)
    v_pk_mul_f32 v[212:213], v[188:189], v[164:165]
    v_pk_mul_f32 v[214:215], v[190:191], v[166:167]
    v_pk_mul_f32 v[216:217], v[192:193], v[168:169]
    v_pk_mul_f32 v[218:219], v[194:195], v[170:171]
    v_pk_fma_f32 v[212:213], v[196:197], v[156:157], v[212:213]
    v_pk_fma_f32 v[214:215], v[198:199], v[158:159], v[214:215]
    v_pk_fma_f32 v[216:217], v[200:201], v[160:161], v[216:217]
    v_pk_fma_f32 v[218:219], v[202:203], v[162:163], v[218:219]
    v_pk_fma_f32 v[212:213], v[172:173], v[148:149], v[212:213]
    v_pk_fma_f32 v[214:215], v[174:175], v[150:151], v[214:215]
    v_pk_fma_f32 v[216:217], v[176:177], v[152:153], v[216:217]
    v_pk_fma_f32 v[218:219], v[178:179], v[154:155], v[218:219]
    v_pk_fma_f32 v[212:213], v[180:181], v[140:141], v[212:213]
    v_pk_fma_f32 v[214:215], v[182:183], v[142:143], v[214:215]
    v_pk_fma_f32 v[216:217], v[184:185], v[144:145], v[216:217]
    v_pk_fma_f32 v[218:219], v[186:187], v[146:147], v[218:219]
    v_lshlrev_b32 v24, 16, v88
    v_and_b32 v25, 0xffff0000, v88
    v_pk_mul_f32 v[212:213], v[212:213], v[24:25]
    v_lshlrev_b32 v24, 16, v89
    v_and_b32 v25, 0xffff0000, v89
    v_pk_mul_f32 v[214:215], v[214:215], v[24:25]
    v_lshlrev_b32 v24, 16, v90
    v_and_b32 v25, 0xffff0000, v90
    v_pk_mul_f32 v[216:217], v[216:217], v[24:25]
    v_lshlrev_b32 v24, 16, v91
    v_and_b32 v25, 0xffff0000, v91
    v_pk_mul_f32 v[218:219], v[218:219], v[24:25]
    v_cvt_pk_bf16_f32 v35, v212, v204
    v_cvt_pk_bf16_f32 v39, v213, v205
    v_cvt_pk_bf16_f32 v43, v214, v206
    v_cvt_pk_bf16_f32 v47, v215, v207
    v_cvt_pk_bf16_f32 v51, v216, v208
    v_cvt_pk_bf16_f32 v55, v217, v209
    v_cvt_pk_bf16_f32 v59, v218, v210
    v_cvt_pk_bf16_f32 v63, v219, v211
    buffer_load_dwordx4 v[116:119], v6, s[64:67], s87 offen offset:1024 nt
    s_waitcnt vmcnt(6)
    v_lshlrev_b32 v188, 16, v92
    v_and_b32 v189, 0xffff0000, v92
    v_lshlrev_b32 v190, 16, v93
    v_and_b32 v191, 0xffff0000, v93
    v_lshlrev_b32 v192, 16, v94
    v_and_b32 v193, 0xffff0000, v94
    v_lshlrev_b32 v194, 16, v95
    v_and_b32 v195, 0xffff0000, v95
    buffer_load_dwordx4 v[120:123], v6, s[68:71], s87 offen offset:1024 nt
    s_waitcnt vmcnt(6)
    v_pk_mul_f32 v[204:205], v[196:197], v[164:165]
    v_pk_mul_f32 v[206:207], v[198:199], v[166:167]
    v_pk_mul_f32 v[208:209], v[200:201], v[168:169]
    v_pk_mul_f32 v[210:211], v[202:203], v[170:171]
    v_pk_fma_f32 v[204:205], v[172:173], v[156:157], v[204:205]
    v_pk_fma_f32 v[206:207], v[174:175], v[158:159], v[206:207]
    v_pk_fma_f32 v[208:209], v[176:177], v[160:161], v[208:209]
    v_pk_fma_f32 v[210:211], v[178:179], v[162:163], v[210:211]
    v_pk_fma_f32 v[204:205], v[180:181], v[148:149], v[204:205]
    v_pk_fma_f32 v[206:207], v[182:183], v[150:151], v[206:207]
    v_pk_fma_f32 v[208:209], v[184:185], v[152:153], v[208:209]
    v_pk_fma_f32 v[210:211], v[186:187], v[154:155], v[210:211]
    v_pk_fma_f32 v[204:205], v[188:189], v[140:141], v[204:205]
    v_pk_fma_f32 v[206:207], v[190:191], v[142:143], v[206:207]
    v_pk_fma_f32 v[208:209], v[192:193], v[144:145], v[208:209]
    v_pk_fma_f32 v[210:211], v[194:195], v[146:147], v[210:211]
    v_lshlrev_b32 v24, 16, v96
    v_and_b32 v25, 0xffff0000, v96
    v_pk_mul_f32 v[204:205], v[204:205], v[24:25]
    v_lshlrev_b32 v24, 16, v97
    v_and_b32 v25, 0xffff0000, v97
    v_pk_mul_f32 v[206:207], v[206:207], v[24:25]
    v_lshlrev_b32 v24, 16, v98
    v_and_b32 v25, 0xffff0000, v98
    v_pk_mul_f32 v[208:209], v[208:209], v[24:25]
    v_lshlrev_b32 v24, 16, v99
    v_and_b32 v25, 0xffff0000, v99
    v_pk_mul_f32 v[210:211], v[210:211], v[24:25]
    buffer_load_dwordx4 v[124:127], v6, s[64:67], s87 offen offset:2048 nt
    s_waitcnt vmcnt(6)
    v_lshlrev_b32 v196, 16, v100
    v_and_b32 v197, 0xffff0000, v100
    v_lshlrev_b32 v198, 16, v101
    v_and_b32 v199, 0xffff0000, v101
    v_lshlrev_b32 v200, 16, v102
    v_and_b32 v201, 0xffff0000, v102
    v_lshlrev_b32 v202, 16, v103
    v_and_b32 v203, 0xffff0000, v103
    buffer_load_dwordx4 v[128:131], v6, s[68:71], s87 offen offset:2048 nt
    s_waitcnt vmcnt(6)
    v_pk_mul_f32 v[212:213], v[172:173], v[164:165]
    v_pk_mul_f32 v[214:215], v[174:175], v[166:167]
    v_pk_mul_f32 v[216:217], v[176:177], v[168:169]
    v_pk_mul_f32 v[218:219], v[178:179], v[170:171]
    v_pk_fma_f32 v[212:213], v[180:181], v[156:157], v[212:213]
    v_pk_fma_f32 v[214:215], v[182:183], v[158:159], v[214:215]
    v_pk_fma_f32 v[216:217], v[184:185], v[160:161], v[216:217]
    v_pk_fma_f32 v[218:219], v[186:187], v[162:163], v[218:219]
    v_pk_fma_f32 v[212:213], v[188:189], v[148:149], v[212:213]
    v_pk_fma_f32 v[214:215], v[190:191], v[150:151], v[214:215]
    v_pk_fma_f32 v[216:217], v[192:193], v[152:153], v[216:217]
    v_pk_fma_f32 v[218:219], v[194:195], v[154:155], v[218:219]
    v_pk_fma_f32 v[212:213], v[196:197], v[140:141], v[212:213]
    v_pk_fma_f32 v[214:215], v[198:199], v[142:143], v[214:215]
    v_pk_fma_f32 v[216:217], v[200:201], v[144:145], v[216:217]
    v_pk_fma_f32 v[218:219], v[202:203], v[146:147], v[218:219]
    v_lshlrev_b32 v24, 16, v104
    v_and_b32 v25, 0xffff0000, v104
    v_pk_mul_f32 v[212:213], v[212:213], v[24:25]
    v_lshlrev_b32 v24, 16, v105
    v_and_b32 v25, 0xffff0000, v105
    v_pk_mul_f32 v[214:215], v[214:215], v[24:25]
    v_lshlrev_b32 v24, 16, v106
    v_and_b32 v25, 0xffff0000, v106
    v_pk_mul_f32 v[216:217], v[216:217], v[24:25]
    v_lshlrev_b32 v24, 16, v107
    v_and_b32 v25, 0xffff0000, v107
    v_pk_mul_f32 v[218:219], v[218:219], v[24:25]
    v_cvt_pk_bf16_f32 v34, v212, v204
    v_cvt_pk_bf16_f32 v38, v213, v205
    v_cvt_pk_bf16_f32 v42, v214, v206
    v_cvt_pk_bf16_f32 v46, v215, v207
    v_cvt_pk_bf16_f32 v50, v216, v208
    v_cvt_pk_bf16_f32 v54, v217, v209
    v_cvt_pk_bf16_f32 v58, v218, v210
    v_cvt_pk_bf16_f32 v62, v219, v211
    buffer_load_dwordx4 v[132:135], v6, s[64:67], s87 offen offset:3072 nt
    s_waitcnt vmcnt(6)
    v_lshlrev_b32 v172, 16, v108
    v_and_b32 v173, 0xffff0000, v108
    v_lshlrev_b32 v174, 16, v109
    v_and_b32 v175, 0xffff0000, v109
    v_lshlrev_b32 v176, 16, v110
    v_and_b32 v177, 0xffff0000, v110
    v_lshlrev_b32 v178, 16, v111
    v_and_b32 v179, 0xffff0000, v111
    buffer_load_dwordx4 v[136:139], v6, s[68:71], s87 offen offset:3072 nt
    s_waitcnt vmcnt(6)
    v_pk_mul_f32 v[204:205], v[180:181], v[164:165]
    v_pk_mul_f32 v[206:207], v[182:183], v[166:167]
    v_pk_mul_f32 v[208:209], v[184:185], v[168:169]
    v_pk_mul_f32 v[210:211], v[186:187], v[170:171]
    v_pk_fma_f32 v[204:205], v[188:189], v[156:157], v[204:205]
    v_pk_fma_f32 v[206:207], v[190:191], v[158:159], v[206:207]
    v_pk_fma_f32 v[208:209], v[192:193], v[160:161], v[208:209]
    v_pk_fma_f32 v[210:211], v[194:195], v[162:163], v[210:211]
    v_pk_fma_f32 v[204:205], v[196:197], v[148:149], v[204:205]
    v_pk_fma_f32 v[206:207], v[198:199], v[150:151], v[206:207]
    v_pk_fma_f32 v[208:209], v[200:201], v[152:153], v[208:209]
    v_pk_fma_f32 v[210:211], v[202:203], v[154:155], v[210:211]
    v_pk_fma_f32 v[204:205], v[172:173], v[140:141], v[204:205]
    v_pk_fma_f32 v[206:207], v[174:175], v[142:143], v[206:207]
    v_pk_fma_f32 v[208:209], v[176:177], v[144:145], v[208:209]
    v_pk_fma_f32 v[210:211], v[178:179], v[146:147], v[210:211]
    v_lshlrev_b32 v24, 16, v112
    v_and_b32 v25, 0xffff0000, v112
    v_pk_mul_f32 v[204:205], v[204:205], v[24:25]
    v_lshlrev_b32 v24, 16, v113
    v_and_b32 v25, 0xffff0000, v113
    v_pk_mul_f32 v[206:207], v[206:207], v[24:25]
    v_lshlrev_b32 v24, 16, v114
    v_and_b32 v25, 0xffff0000, v114
    v_pk_mul_f32 v[208:209], v[208:209], v[24:25]
    v_lshlrev_b32 v24, 16, v115
    v_and_b32 v25, 0xffff0000, v115
    v_pk_mul_f32 v[210:211], v[210:211], v[24:25]
    s_waitcnt vmcnt(5)
    v_lshlrev_b32 v180, 16, v116
    v_and_b32 v181, 0xffff0000, v116
    v_lshlrev_b32 v182, 16, v117
    v_and_b32 v183, 0xffff0000, v117
    v_lshlrev_b32 v184, 16, v118
    v_and_b32 v185, 0xffff0000, v118
    v_lshlrev_b32 v186, 16, v119
    v_and_b32 v187, 0xffff0000, v119
    s_waitcnt vmcnt(4)
    v_pk_mul_f32 v[212:213], v[188:189], v[164:165]
    v_pk_mul_f32 v[214:215], v[190:191], v[166:167]
    v_pk_mul_f32 v[216:217], v[192:193], v[168:169]
    v_pk_mul_f32 v[218:219], v[194:195], v[170:171]
    v_pk_fma_f32 v[212:213], v[196:197], v[156:157], v[212:213]
    v_pk_fma_f32 v[214:215], v[198:199], v[158:159], v[214:215]
    v_pk_fma_f32 v[216:217], v[200:201], v[160:161], v[216:217]
    v_pk_fma_f32 v[218:219], v[202:203], v[162:163], v[218:219]
    v_pk_fma_f32 v[212:213], v[172:173], v[148:149], v[212:213]
    v_pk_fma_f32 v[214:215], v[174:175], v[150:151], v[214:215]
    v_pk_fma_f32 v[216:217], v[176:177], v[152:153], v[216:217]
    v_pk_fma_f32 v[218:219], v[178:179], v[154:155], v[218:219]
    v_pk_fma_f32 v[212:213], v[180:181], v[140:141], v[212:213]
    v_pk_fma_f32 v[214:215], v[182:183], v[142:143], v[214:215]
    v_pk_fma_f32 v[216:217], v[184:185], v[144:145], v[216:217]
    v_pk_fma_f32 v[218:219], v[186:187], v[146:147], v[218:219]
    v_lshlrev_b32 v24, 16, v120
    v_and_b32 v25, 0xffff0000, v120
    v_pk_mul_f32 v[212:213], v[212:213], v[24:25]
    v_lshlrev_b32 v24, 16, v121
    v_and_b32 v25, 0xffff0000, v121
    v_pk_mul_f32 v[214:215], v[214:215], v[24:25]
    v_lshlrev_b32 v24, 16, v122
    v_and_b32 v25, 0xffff0000, v122
    v_pk_mul_f32 v[216:217], v[216:217], v[24:25]
    v_lshlrev_b32 v24, 16, v123
    v_and_b32 v25, 0xffff0000, v123
    v_pk_mul_f32 v[218:219], v[218:219], v[24:25]
    v_cvt_pk_bf16_f32 v33, v212, v204
    v_cvt_pk_bf16_f32 v37, v213, v205
    v_cvt_pk_bf16_f32 v41, v214, v206
    v_cvt_pk_bf16_f32 v45, v215, v207
    v_cvt_pk_bf16_f32 v49, v216, v208
    v_cvt_pk_bf16_f32 v53, v217, v209
    v_cvt_pk_bf16_f32 v57, v218, v210
    v_cvt_pk_bf16_f32 v61, v219, v211
    buffer_load_dword v29, off, s[60:63], 0 sc1
    s_waitcnt vmcnt(4)
    v_lshlrev_b32 v188, 16, v124
    v_and_b32 v189, 0xffff0000, v124
    v_lshlrev_b32 v190, 16, v125
    v_and_b32 v191, 0xffff0000, v125
    v_lshlrev_b32 v192, 16, v126
    v_and_b32 v193, 0xffff0000, v126
    v_lshlrev_b32 v194, 16, v127
    v_and_b32 v195, 0xffff0000, v127
    s_waitcnt vmcnt(3)
    v_pk_mul_f32 v[204:205], v[196:197], v[164:165]
    v_pk_mul_f32 v[206:207], v[198:199], v[166:167]
    v_pk_mul_f32 v[208:209], v[200:201], v[168:169]
    v_pk_mul_f32 v[210:211], v[202:203], v[170:171]
    v_pk_fma_f32 v[204:205], v[172:173], v[156:157], v[204:205]
    v_pk_fma_f32 v[206:207], v[174:175], v[158:159], v[206:207]
    v_pk_fma_f32 v[208:209], v[176:177], v[160:161], v[208:209]
    v_pk_fma_f32 v[210:211], v[178:179], v[162:163], v[210:211]
    v_pk_fma_f32 v[204:205], v[180:181], v[148:149], v[204:205]
    v_pk_fma_f32 v[206:207], v[182:183], v[150:151], v[206:207]
    v_pk_fma_f32 v[208:209], v[184:185], v[152:153], v[208:209]
    v_pk_fma_f32 v[210:211], v[186:187], v[154:155], v[210:211]
    v_pk_fma_f32 v[204:205], v[188:189], v[140:141], v[204:205]
    v_pk_fma_f32 v[206:207], v[190:191], v[142:143], v[206:207]
    v_pk_fma_f32 v[208:209], v[192:193], v[144:145], v[208:209]
    v_pk_fma_f32 v[210:211], v[194:195], v[146:147], v[210:211]
    v_lshlrev_b32 v24, 16, v128
    v_and_b32 v25, 0xffff0000, v128
    v_pk_mul_f32 v[204:205], v[204:205], v[24:25]
    v_lshlrev_b32 v24, 16, v129
    v_and_b32 v25, 0xffff0000, v129
    v_pk_mul_f32 v[206:207], v[206:207], v[24:25]
    v_lshlrev_b32 v24, 16, v130
    v_and_b32 v25, 0xffff0000, v130
    v_pk_mul_f32 v[208:209], v[208:209], v[24:25]
    v_lshlrev_b32 v24, 16, v131
    v_and_b32 v25, 0xffff0000, v131
    v_pk_mul_f32 v[210:211], v[210:211], v[24:25]
    s_waitcnt vmcnt(2)
    v_lshlrev_b32 v196, 16, v132
    v_and_b32 v197, 0xffff0000, v132
    v_lshlrev_b32 v198, 16, v133
    v_and_b32 v199, 0xffff0000, v133
    v_lshlrev_b32 v200, 16, v134
    v_and_b32 v201, 0xffff0000, v134
    v_lshlrev_b32 v202, 16, v135
    v_and_b32 v203, 0xffff0000, v135
    s_waitcnt vmcnt(1)
    v_pk_mul_f32 v[212:213], v[172:173], v[164:165]
    v_pk_mul_f32 v[214:215], v[174:175], v[166:167]
    v_pk_mul_f32 v[216:217], v[176:177], v[168:169]
    v_pk_mul_f32 v[218:219], v[178:179], v[170:171]
    v_pk_fma_f32 v[212:213], v[180:181], v[156:157], v[212:213]
    v_pk_fma_f32 v[214:215], v[182:183], v[158:159], v[214:215]
    v_pk_fma_f32 v[216:217], v[184:185], v[160:161], v[216:217]
    v_pk_fma_f32 v[218:219], v[186:187], v[162:163], v[218:219]
    v_pk_fma_f32 v[212:213], v[188:189], v[148:149], v[212:213]
    v_pk_fma_f32 v[214:215], v[190:191], v[150:151], v[214:215]
    v_pk_fma_f32 v[216:217], v[192:193], v[152:153], v[216:217]
    v_pk_fma_f32 v[218:219], v[194:195], v[154:155], v[218:219]
    v_pk_fma_f32 v[212:213], v[196:197], v[140:141], v[212:213]
    v_pk_fma_f32 v[214:215], v[198:199], v[142:143], v[214:215]
    v_pk_fma_f32 v[216:217], v[200:201], v[144:145], v[216:217]
    v_pk_fma_f32 v[218:219], v[202:203], v[146:147], v[218:219]
    v_lshlrev_b32 v24, 16, v136
    v_and_b32 v25, 0xffff0000, v136
    v_pk_mul_f32 v[212:213], v[212:213], v[24:25]
    v_lshlrev_b32 v24, 16, v137
    v_and_b32 v25, 0xffff0000, v137
    v_pk_mul_f32 v[214:215], v[214:215], v[24:25]
    v_lshlrev_b32 v24, 16, v138
    v_and_b32 v25, 0xffff0000, v138
    v_pk_mul_f32 v[216:217], v[216:217], v[24:25]
    v_lshlrev_b32 v24, 16, v139
    v_and_b32 v25, 0xffff0000, v139
    v_pk_mul_f32 v[218:219], v[218:219], v[24:25]
    v_cvt_pk_bf16_f32 v32, v212, v204
    v_cvt_pk_bf16_f32 v36, v213, v205
    v_cvt_pk_bf16_f32 v40, v214, v206
    v_cvt_pk_bf16_f32 v44, v215, v207
    v_cvt_pk_bf16_f32 v48, v216, v208
    v_cvt_pk_bf16_f32 v52, v217, v209
    v_cvt_pk_bf16_f32 v56, v218, v210
    v_cvt_pk_bf16_f32 v60, v219, v211
    ds_write_b128 v10, v[32:35] offset:0
    ds_write_b128 v10, v[36:39] offset:128
    ds_write_b128 v10, v[40:43] offset:256
    ds_write_b128 v10, v[44:47] offset:384
    ds_write_b128 v10, v[48:51] offset:512
    ds_write_b128 v10, v[52:55] offset:640
    ds_write_b128 v10, v[56:59] offset:768
    ds_write_b128 v10, v[60:63] offset:896
    v_xor_b32 v13, 0, v11
    ds_read_b128 v[32:35], v13 offset:0
    v_xor_b32 v13, 16, v11
    ds_read_b128 v[36:39], v13 offset:1024
    v_xor_b32 v13, 32, v11
    ds_read_b128 v[40:43], v13 offset:2048
    v_xor_b32 v13, 48, v11
    ds_read_b128 v[44:47], v13 offset:3072
    v_xor_b32 v13, 64, v11
    ds_read_b128 v[48:51], v13 offset:4096
    v_xor_b32 v13, 80, v11
    ds_read_b128 v[52:55], v13 offset:5120
    v_xor_b32 v13, 96, v11
    ds_read_b128 v[56:59], v13 offset:6144
    v_xor_b32 v13, 112, v11
    ds_read_b128 v[60:63], v13 offset:7168
    s_waitcnt lgkmcnt(7)
    buffer_store_dwordx4 v[32:35], v12, s[48:51], s73 offen sc1
    s_waitcnt lgkmcnt(6)
    s_add_u32 s73, s73, 32768
    buffer_store_dwordx4 v[36:39], v12, s[48:51], s73 offen sc1
    s_waitcnt lgkmcnt(5)
    s_add_u32 s73, s73, 32768
    buffer_store_dwordx4 v[40:43], v12, s[48:51], s73 offen sc1
    s_waitcnt lgkmcnt(4)
    s_add_u32 s73, s73, 32768
    buffer_store_dwordx4 v[44:47], v12, s[48:51], s73 offen sc1
    s_waitcnt lgkmcnt(3)
    s_add_u32 s73, s73, 32768
    buffer_store_dwordx4 v[48:51], v12, s[48:51], s73 offen sc1
    s_waitcnt lgkmcnt(2)
    s_add_u32 s73, s73, 32768
    buffer_store_dwordx4 v[52:55], v12, s[48:51], s73 offen sc1
    s_waitcnt lgkmcnt(1)
    s_add_u32 s73, s73, 32768
    buffer_store_dwordx4 v[56:59], v12, s[48:51], s73 offen sc1
    s_waitcnt lgkmcnt(0)
    s_add_u32 s73, s73, 32768
    buffer_store_dwordx4 v[60:63], v12, s[48:51], s73 offen sc1
    s_barrier
    s_waitcnt vmcnt(8)
BACKN_56:
    v_readfirstlane_b32 s89, v29
    s_nop 0
    s_cmp_eq_u32 s89, 0
    s_cbranch_scc1 SLOWN_55
OKN_57:
    s_waitcnt vmcnt(0)
    v_mov_b32 v12, s89
    s_mov_b64 exec, 1
    buffer_store_dword v12, off, s[48:51], s75 sc1
    s_mov_b64 exec, -1
    s_cmp_lt_u32 s100, 4
    s_cbranch_scc1 L_HA
    s_mov_b32 s52, s12
    s_and_b32 s53, s13, 0xffff
    s_mov_b32 s54, 2097152
    s_mov_b32 s55, 0x00020000
    v_mov_b32 v31, 152064
    s_and_b32 s21, s90, 3
    s_mul_i32 s21, s21, 7
    s_add_u32 s21, s21, 1
    s_lshr_b32 s21, s21, 1
    s_lshl_b32 s92, s91, 7
    s_add_u32 s44, s22, s92
    s_addc_u32 s45, s23, 0
    s_and_b32 s45, s45, 0xffff
    s_mov_b32 s46, 1834112
    s_mov_b32 s47, 0x00020000
    s_mul_i32 s92, s80, 458752
    s_add_u32 s99, s92, 458752
    s_lshl_b32 s93, s21, 15
    s_add_u32 s98, s92, s93
    s_and_b32 s64, s91, 3
    s_xor_b32 s65, s64, 1
    s_xor_b32 s66, s64, 2
    s_xor_b32 s67, s64, 3
    s_mul_i32 s20, s80, 14336
    s_add_u32 s20, s20, 45056
    v_add_u32 v2, s20, v30
    s_mul_i32 s19, s90, 229376
    s_add_u32 s19, s19, 8388608
    s_mul_i32 s93, s80, 14336
    s_add_u32 s69, s19, s93
    s_sub_u32 s69, s69, s20
    s_lshl_b32 s92, s91, 2
    s_add_u32 s92, s92, s80
    s_mul_i32 s92, s92, 7168
    s_add_u32 s19, s19, s92
    s_lshl_b32 s18, s90, 12
    s_add_u32 s18, s18, 393216
    s_mul_i32 s31, s81, 17408
    s_lshl_b32 s72, s30, 12
    s_lshl_b32 s92, s82, 3
    s_add_u32 s72, s72, s92
    s_add_u32 s73, s72, 4
    s_mul_i32 s74, s82, 8592
    s_add_u32 s74, s74, 224
    s_add_u32 s74, s74, s31
    s_mul_i32 s92, s82, 8832
    s_add_u32 s92, s92, 114720
    s_add_u32 s92, s92, s31
    s_mul_i32 s75, s82, 8832
    s_add_u32 s75, s75, 4400
    s_add_u32 s75, s75, s31
    s_mul_i32 s93, s82, 8832
    s_add_u32 s93, s93, 119136
    s_add_u32 s93, s93, s31
    v_add_u32 v8, s92, v30
    v_add_u32 v9, s93, v30
    v_bfe_u32 v16, v1, 1, 3
    v_add_u32 v17, 7, v16
    v_and_b32 v17, 7, v17
    v_lshrrev_b32 v18, 1, v17
    v_and_b32 v17, 1, v17
    v_lshl_add_u32 v17, v18, 2, v17
    v_min_u32 v17, 12, v17
    v_lshlrev_b32 v17, 4, v17
    v_and_b32 v18, 1, v16
    v_mul_u32_u24 v18, 114688, v18
    v_lshrrev_b32 v16, 1, v16
    v_mul_u32_u24 v16, 4352, v16
    v_add3_u32 v17, v16, v17, v18
    v_and_b32 v18, 1, v1
    v_lshl_add_u32 v17, v18, 4, v17
    v_add_u32 v10, s31, v17
    s_lshl_b32 s92, s81, 6
    s_add_u32 s92, s92, 149504
    v_and_b32 v16, 14, v1
    v_add_u32 v16, 16, v16
    v_mul_u32_u24 v16, v16, v18
    v_add_u32 v12, s92, v16
    v_mov_b32 v13, s92
    v_mov_b32 v14, 0
    v_mov_b32 v15, 0
    s_mul_i32 s31, s81, 4608
    s_add_u32 s31, s31, 34816
    v_lshl_add_u32 v11, v1, 3, s31
    s_lshl_b32 s92, s82, 11
    s_add_u32 s31, s31, s92
    s_lshl_b32 s93, s30, 12
    s_add_u32 s93, s93, s92
    s_add_u32 s9, s93, 1048576
    s_lshl_b32 s22, s80, 12
    s_add_u32 s22, s22, 102400
    s_cmp_eq_u32 s80, 3
    s_cselect_b32 s22, 154112, s22
    v_lshrrev_b32 v17, 3, v1
    v_bfe_u32 v18, v1, 1, 2
    v_bfe_u32 v19, v1, 4, 2
    v_xor_b32 v18, v18, v19
    v_lshlrev_b32 v17, 10, v17
    v_lshl_or_b32 v17, v18, 5, v17
    v_and_b32 v18, 1, v1
    v_lshl_or_b32 v16, v18, 4, v17
    v_bfe_u32 v17, v1, 2, 3
    v_lshrrev_b32 v18, 5, v1
    v_lshlrev_b32 v18, 10, v18
    v_lshl_or_b32 v18, v17, 7, v18
    v_and_b32 v19, 3, v1
    v_lshl_or_b32 v18, v19, 3, v18
    v_lshrrev_b32 v17, 1, v17
    v_lshl_add_u32 v18, v17, 5, v18
    v_add_u32 v20, s22, v18
    v_xor_b32 v21, 32, v20
    v_xor_b32 v22, 64, v20
    v_xor_b32 v23, 0x60, v20
    v_add_u32 v17, 7168, v16
    v_add_u32 v18, 14336, v16
    v_add_u32 v19, 21504, v16
    buffer_load_dwordx4 v[192:195], v30, s[52:55], s72 offen offset:0
    buffer_load_dwordx4 v[198:201], v30, s[52:55], s72 offen offset:1024
    buffer_load_dwordx4 v[204:207], v30, s[52:55], s72 offen offset:2048
    buffer_load_dwordx4 v[210:213], v30, s[52:55], s72 offen offset:3072
    s_add_u32 m0, s22, 0
    s_nop 0
    buffer_load_dwordx4 v16, s[44:47], s98 offen offset:0 lds
    buffer_load_dwordx4 v17, s[44:47], s98 offen offset:1024 lds
    buffer_load_dwordx4 v18, s[44:47], s98 offen offset:2048 lds
    buffer_load_dwordx4 v19, s[44:47], s98 offen offset:3072 lds
    s_lshl_b32 s70, s21, 10
    s_add_u32 s32, s69, s70
    s_cmp_eq_u32 s21, 11
    s_cselect_b32 s70, 14336, 0
    s_sub_u32 s33, s32, s70
    s_add_u32 s34, s33, 4096
    s_cmp_eq_u32 s21, 7
    s_cselect_b32 s70, 14336, 0
    s_sub_u32 s35, s34, s70
    s_add_u32 s36, s35, 4096
    s_cmp_eq_u32 s21, 4
    s_cselect_b32 s70, 14336, 0
    s_sub_u32 s37, s36, s70
    s_add_u32 s38, s37, 4096
    s_waitcnt vmcnt(6)
    s_mov_b64 vcc, 1
    v_cndmask_b32 v196, v192, v198, vcc
    v_cndmask_b32 v197, v193, v199, vcc
    s_nop 0
    v_mov_b32_dpp v196, v196 wave_rol:1 row_mask:0xf bank_mask:0xf
    v_mov_b32_dpp v197, v197 wave_rol:1 row_mask:0xf bank_mask:0xf
    v_alignbit_b32 v160, v193, v192, 16
    v_alignbit_b32 v161, v194, v193, 16
    v_alignbit_b32 v162, v195, v194, 16
    v_alignbit_b32 v163, v196, v195, 16
    v_alignbit_b32 v164, v194, v193, 16
    v_alignbit_b32 v165, v195, v194, 16
    v_alignbit_b32 v166, v196, v195, 16
    v_alignbit_b32 v167, v197, v196, 16
    s_waitcnt vmcnt(5)
    s_mov_b64 vcc, 1
    v_cndmask_b32 v202, v198, v204, vcc
    v_cndmask_b32 v203, v199, v205, vcc
    s_nop 0
    v_mov_b32_dpp v202, v202 wave_rol:1 row_mask:0xf bank_mask:0xf
    v_mov_b32_dpp v203, v203 wave_rol:1 row_mask:0xf bank_mask:0xf
    v_alignbit_b32 v168, v199, v198, 16
    v_alignbit_b32 v169, v200, v199, 16
    v_alignbit_b32 v170, v201, v200, 16
    v_alignbit_b32 v171, v202, v201, 16
    v_alignbit_b32 v172, v200, v199, 16
    v_alignbit_b32 v173, v201, v200, 16
    v_alignbit_b32 v174, v202, v201, 16
    v_alignbit_b32 v175, v203, v202, 16
    s_waitcnt vmcnt(4)
    s_mov_b64 vcc, 1
    v_cndmask_b32 v208, v204, v210, vcc
    v_cndmask_b32 v209, v205, v211, vcc
    s_nop 0
    v_mov_b32_dpp v208, v208 wave_rol:1 row_mask:0xf bank_mask:0xf
    v_mov_b32_dpp v209, v209 wave_rol:1 row_mask:0xf bank_mask:0xf
    v_alignbit_b32 v176, v205, v204, 16
    v_alignbit_b32 v177, v206, v205, 16
    v_alignbit_b32 v178, v207, v206, 16
    v_alignbit_b32 v179, v208, v207, 16
    v_alignbit_b32 v180, v206, v205, 16
    v_alignbit_b32 v181, v207, v206, 16
    v_alignbit_b32 v182, v208, v207, 16
    v_alignbit_b32 v183, v209, v208, 16
    s_waitcnt vmcnt(4)
    s_mov_b64 vcc, 1
    v_cndmask_b32 v214, v210, v210, vcc
    v_cndmask_b32 v215, v211, v211, vcc
    s_nop 0
    v_mov_b32_dpp v214, v214 wave_rol:1 row_mask:0xf bank_mask:0xf
    v_mov_b32_dpp v215, v215 wave_rol:1 row_mask:0xf bank_mask:0xf
    v_alignbit_b32 v184, v211, v210, 16
    v_alignbit_b32 v185, v212, v211, 16
    v_alignbit_b32 v186, v213, v212, 16
    v_alignbit_b32 v187, v214, v213, 16
    v_alignbit_b32 v188, v212, v211, 16
    v_alignbit_b32 v189, v213, v212, 16
    v_alignbit_b32 v190, v214, v213, 16
    v_alignbit_b32 v191, v215, v214, 16
    s_waitcnt vmcnt(0)
    ds_read_b64_tr_b16 v[32:33], v20 offset:0
    ds_read_b64_tr_b16 v[34:35], v20 offset:2048
    ds_read_b64_tr_b16 v[36:37], v21 offset:0
    ds_read_b64_tr_b16 v[38:39], v21 offset:2048
    ds_read_b64_tr_b16 v[40:41], v22 offset:0
    ds_read_b64_tr_b16 v[42:43], v22 offset:2048
    ds_read_b64_tr_b16 v[44:45], v23 offset:0
    ds_read_b64_tr_b16 v[46:47], v23 offset:2048
    s_waitcnt lgkmcnt(0)
    s_add_u32 s98, s98, 32768
    s_cmp_eq_u32 s98, s99
    s_cselect_b32 s94, 458752, 0
    s_sub_u32 s98, s98, s94
    s_add_u32 m0, s22, 0
    s_nop 0
    buffer_load_dwordx4 v16, s[44:47], s98 offen offset:0 lds
    buffer_load_dwordx4 v17, s[44:47], s98 offen offset:1024 lds
    buffer_load_dwordx4 v18, s[44:47], s98 offen offset:2048 lds
    buffer_load_dwordx4 v19, s[44:47], s98 offen offset:3072 lds
    ds_write_b128 v8, v[160:163] offset:0
    ds_write_b128 v9, v[164:167] offset:0
    ds_write_b128 v8, v[168:171] offset:1024
    ds_write_b128 v9, v[172:175] offset:1024
    ds_write_b128 v8, v[176:179] offset:2048
    ds_write_b128 v9, v[180:183] offset:2048
    ds_write_b128 v8, v[184:187] offset:3072
    ds_write_b128 v9, v[188:191] offset:3072
    s_cmp_lg_u32 s82, 0
    s_cbranch_scc1 HD_58
    s_mov_b64 exec, 1
    ds_write_b64 v13, v[14:15] offset:0
    ds_write_b64 v13, v[14:15] offset:8
    ds_write_b64 v13, v[14:15] offset:16
    ds_write_b64 v13, v[14:15] offset:24
    ds_write_b128 v13, v[192:195] offset:32
    s_mov_b64 exec, -1
    ds_read_b128 v[24:27], v12
    s_waitcnt lgkmcnt(0)
HD_58:
    s_sleep 16
    v_and_b32 v217, 31, v1
    v_lshlrev_b32 v217, 2, v217
    s_lshr_b32 s7, s2, 5
    s_lshl_b32 s7, s7, 7
    s_add_u32 s7, s7, 0
    buffer_load_dword v216, v217, s[48:51], s7 offen sc1
    s_waitcnt vmcnt(0)
BACK_60:
    v_cmp_ne_u32 vcc, s89, v216
    s_nop 0
    s_cbranch_vccnz SLOW_59
OK_61:
    s_mov_b32 m0, s31
    s_nop 0
    buffer_load_dwordx4 v30, s[48:51], s9 offen offset:0 sc1 lds
    buffer_load_dwordx4 v30, s[48:51], s9 offen offset:1024 sc1 lds
    s_branch L_B1
L_HA:
    s_mov_b32 s3, 0
    v_lshlrev_b32 v24, 4, v1
    v_and_b32 v27, 15, v1
    v_lshrrev_b32 v28, 4, v1
    v_and_b32 v29, 7, v27
    v_lshrrev_b32 v30, 1, v29
    v_and_b32 v29, 1, v29
    v_lshl_add_u32 v29, v30, 2, v29
    v_min_u32 v29, 12, v29
    v_add_u32 v30, 1, v27
    v_lshrrev_b32 v26, 3, v30
    v_and_b32 v30, 7, v30
    v_add3_u32 v29, v29, v26, v28
    v_lshlrev_b32 v29, 4, v29
    v_and_b32 v25, 1, v30
    v_mul_u32_u24 v25, 114688, v25
    v_lshrrev_b32 v30, 1, v30
    v_mul_u32_u24 v30, 4352, v30
    v_add_u32 v29, v29, v25
    s_mul_i32 s93, s81, 17408
    s_lshl_b32 s92, s82, 8
    s_add_u32 s93, s93, s92
    v_add3_u32 v25, v29, v30, s93
    v_lshlrev_b32 v29, 5, v27
    v_lshlrev_b32 v30, 4, v28
    v_sub_u32 v29, v30, v29
    s_mul_i32 s93, s81, 4608
    s_add_u32 s93, s93, s92
    s_add_u32 s93, s93, 35296
    v_add_u32 v26, s93, v29
    v_mov_b32 v0, 152064
    s_and_b32 s64, s91, 3
    s_xor_b32 s65, s64, 1
    s_xor_b32 s66, s64, 2
    s_xor_b32 s67, s64, 3
    s_mov_b32 s56, s24
    s_and_b32 s57, s25, 0xffff
    s_mov_b32 s58, 2097152
    s_mov_b32 s59, 0x00020000
    s_mov_b32 s32, s4
    s_and_b32 s33, s5, 0xffff
    s_mov_b32 s34, 2097152
    s_mov_b32 s35, 0x00020000
    s_mov_b32 s101, 0xbfb8aa3b
    s_lshl_b32 s72, s90, 16
    s_add_u32 s72, s72, s95
    s_lshl_b32 s93, s91, 7
    s_add_u32 s72, s72, s93
    s_lshl_b32 s68, s64, 14
    s_add_u32 s68, s68, s72
    s_lshl_b32 s69, s65, 14
    s_add_u32 s69, s69, s72
    s_lshl_b32 s70, s66, 14
    s_add_u32 s70, s70, s72
    s_lshl_b32 s71, s67, 14
    s_add_u32 s71, s71, s72
    s_lshl_b32 s73, s90, 10
    s_lshl_b32 s93, s80, 6
    s_add_u32 s73, s73, s93
    s_add_u32 s73, s73, 65536
    s_lshl_b32 s74, s90, 3
    s_add_u32 s74, s74, 20480
    s_lshl_b32 s75, s91, 18
    s_lshl_b32 s93, s80, 16
    s_add_u32 s75, s75, s93
    s_lshl_b32 s93, s90, 7
    s_add_u32 s75, s75, s93
    s_add_u32 s75, s75, 4194304
    s_add_u32 s76, s75, 31744
    s_lshl_b32 s93, s82, 11
    s_lshl_b32 s77, s30, 12
    s_add_u32 s77, s77, s93
    s_add_u32 s77, s77, 4194304
    s_lshl_b32 s78, s30, 2
    s_add_u32 s78, s78, s93
    s_add_u32 s78, s78, 16384
    s_lshr_b32 s79, s90, 4
    s_lshl_b32 s79, s79, 11
    s_lshl_b32 s93, s91, 8
    s_add_u32 s79, s79, s93
    s_add_u32 s79, s79, 16384
    s_lshl_b32 s36, s80, 11
    s_getpc_b64 s[40:41]
PC_62:
    s_sub_u32 s40, s40, PC_62-recurrent_scan__ssm_conv_h3__glu_gated_swiglu__prompt_kernel
    s_subb_u32 s41, s41, 0
    s_and_b32 s41, s41, 0xffff
    s_mov_b32 s42, L_CODE_END-recurrent_scan__ssm_conv_h3__glu_gated_swiglu__prompt_kernel
    s_mov_b32 s43, 0x00020000
    v_min_u32 v2, 19, v1
    v_lshlrev_b32 v2, 7, v2
    s_lshr_b32 s92, s2, 3
    s_lshl_b32 s92, s92, 2
    s_add_u32 s92, s92, s80
    s_mul_i32 s92, s92, 2560
    buffer_load_dword v195, v2, s[40:43], s92 offen
    v_mov_b32 v16, -1
    v_mov_b32 v17, -1
    v_mov_b32 v18, -1
    v_mov_b32 v19, -1
    buffer_store_dwordx4 v[16:19], v24, s[48:51], s77 offen offset:0 sc1
    buffer_store_dwordx4 v[16:19], v24, s[48:51], s77 offen offset:1024 sc1
    s_waitcnt vmcnt(0)
    v_mov_b32 v27, s89
    s_mov_b64 exec, 1
    buffer_store_dword v27, off, s[48:51], s78 sc1
    s_mov_b64 exec, -1
    s_branch L_A2
SLOWN_5:
    s_cmp_eq_u32 s96, 0
    s_cbranch_scc1 OKN_7
    s_sub_u32 s96, s96, 1
    s_sleep 24
    buffer_load_dword v27, off, s[60:63], 0 sc1
    s_waitcnt vmcnt(0)
    s_branch BACKN_6
SLOW_8:
    s_cmp_eq_u32 s96, 0
    s_cbranch_scc1 OK_10
    s_sub_u32 s96, s96, 1
    s_sleep 24
    buffer_load_dword v24, v25, s[48:51], s10 offen sc1
    buffer_load_dword v26, v28, s[48:51], s11 offen sc1
    s_waitcnt vmcnt(0)
    s_branch BACK_9
LS_12:
    s_cmp_eq_u32 s96, 0
    s_cbranch_scc1 LO_14
    s_sub_u32 s96, s96, 1
    s_sleep 1
    ds_read_b128 v[220:223], v31 offset:16
    s_waitcnt lgkmcnt(0)
    s_branch LB_13
SLOW_15:
    s_cmp_eq_u32 s96, 0
    s_cbranch_scc1 OK_17
    s_sub_u32 s96, s96, 1
    s_sleep 48
    buffer_load_dword v216, v217, s[48:51], s7 offen sc1
    s_waitcnt vmcnt(0)
    s_branch BACK_16
LS_19:
    s_cmp_eq_u32 s96, 0
    s_cbranch_scc1 LO_21
    s_sub_u32 s96, s96, 1
    s_sleep 2
    ds_read_b128 v[8:11], v31 offset:48
    s_waitcnt lgkmcnt(0)
    s_branch LB_20
SLOW_22:
    s_cmp_eq_u32 s96, 0
    s_cbranch_scc1 OK_24
    s_sub_u32 s96, s96, 1
    s_sleep 24
    buffer_load_dword v24, v25, s[48:51], s18 offen sc1
    s_waitcnt vmcnt(0)
    s_branch BACK_23
LS_25:
    s_cmp_eq_u32 s96, 0
    s_cbranch_scc1 LO_27
    s_sub_u32 s96, s96, 1
    s_sleep 1
    ds_read_b128 v[8:11], v0 offset:64
    s_waitcnt lgkmcnt(0)
    s_branch LB_26
SLOWN_28:
    s_cmp_eq_u32 s96, 0
    s_cbranch_scc1 OKN_30
    s_sub_u32 s96, s96, 1
    s_sleep 24
    buffer_load_dword v27, off, s[60:63], 0 sc1
    s_waitcnt vmcnt(0)
    s_branch BACKN_29
LS_31:
    s_cmp_eq_u32 s96, 0
    s_cbranch_scc1 LO_33
    s_sub_u32 s96, s96, 1
    s_sleep 1
    ds_read_b128 v[12:15], v0 offset:0
    s_waitcnt lgkmcnt(0)
    s_branch LB_32
LS_34:
    s_cmp_eq_u32 s96, 0
    s_cbranch_scc1 LO_36
    s_sub_u32 s96, s96, 1
    s_sleep 1
    ds_read_b128 v[32:35], v0 offset:32
    s_waitcnt lgkmcnt(0)
    s_branch LB_35
LS_41:
    s_cmp_eq_u32 s96, 0
    s_cbranch_scc1 LO_43
    s_sub_u32 s96, s96, 1
    s_sleep 0
    ds_read_b128 v[32:35], v0 offset:64
    s_waitcnt lgkmcnt(0)
    s_branch LB_42
SLOW_45:
    s_cmp_eq_u32 s96, 0
    s_cbranch_scc1 OK_47
    s_sub_u32 s96, s96, 1
    s_sleep 16
    buffer_load_dword v28, off, s[48:51], s92 sc1
    s_waitcnt vmcnt(0)
    s_branch BACK_46
SLOW_48:
    s_cmp_eq_u32 s96, 0
    s_cbranch_scc1 OK_50
    s_sub_u32 s96, s96, 1
    s_sleep 24
    buffer_load_dword v16, v17, s[48:51], s74 offen sc1
    buffer_load_dword v23, v27, s[48:51], s79 offen sc1
    s_waitcnt vmcnt(0)
    s_branch BACK_49
YS_52:
    s_cmp_eq_u32 s96, 0
    s_cbranch_scc1 YO_53
    s_sub_u32 s96, s96, 1
    s_sleep 4
    buffer_load_dwordx4 v6, s[48:51], s75 offen sc1 lds
    buffer_load_dwordx4 v7, s[48:51], s76 offen offset:1024 sc1 lds
    s_waitcnt vmcnt(0)
    s_branch YB_51
SLOWN_55:
    s_cmp_eq_u32 s96, 0
    s_cbranch_scc1 OKN_57
    s_sub_u32 s96, s96, 1
    s_sleep 24
    buffer_load_dword v29, off, s[60:63], 0 sc1
    s_waitcnt vmcnt(0)
    s_branch BACKN_56
SLOW_59:
    s_cmp_eq_u32 s96, 0
    s_cbranch_scc1 OK_61
    s_sub_u32 s96, s96, 1
    s_sleep 48
    buffer_load_dword v216, v217, s[48:51], s7 offen sc1
    s_waitcnt vmcnt(0)
    s_branch BACK_60
L_CODE_END:
    s_endpgm

.section .rodata,"a"
.p2align 6
.amdhsa_kernel recurrent_scan__ssm_conv_h3__glu_gated_swiglu__prompt_kernel
  .amdhsa_next_free_vgpr 256
  .amdhsa_next_free_sgpr 102
  .amdhsa_accum_offset 224
  .amdhsa_group_segment_fixed_size 0
  .amdhsa_kernarg_size 104
  .amdhsa_user_sgpr_count 2
  .amdhsa_user_sgpr_kernarg_segment_ptr 1
  .amdhsa_system_sgpr_workgroup_id_x 1
.end_amdhsa_kernel
```
